```python
import torch

def _softmax(x, axis=-1):
    return torch.softmax(x, dim=axis)
def _gelu(x):
    return torch.nn.functional.gelu(x, approximate="tanh")
def _silu(x):
    return torch.nn.functional.silu(x)
def _sigmoid(x):
    return torch.sigmoid(x)
def _layernorm(x, axis=-1, eps=1e-5):
    m = x.mean(dim=axis, keepdim=True)
    v = x.var(dim=axis, keepdim=True, unbiased=False)
    return (x - m) / torch.sqrt(v + eps)
def _scatter_add(tgt, idx, src, axis=0):
    return tgt.clone().index_add_(axis, idx, src)
def _segment_sum(src, seg, n):
    out = torch.zeros((n,) + src.shape[1:], dtype=src.dtype)
    return out.index_add_(0, seg, src)
def _pad(x, pw):
    flat = tuple(v for pair in reversed(pw) for v in pair)
    return torch.nn.functional.pad(x, flat)

kernel_name = 'recurrent_scan__grouped_kv_mqa__swiglu_ffn__prompt'

def setup_inputs():

    _w = (lambda a: (lambda t: t.to(torch.bfloat16) if t.is_floating_point() else t)(torch.as_tensor(a)))
    def _A_setup():
        B, S, D, H = 1, 2048, 640, 32
        Dh = D // H
        return {
            "x": _w((lambda *s: torch.randn(*s, dtype=torch.bfloat16) * 0.05)(B, S, D)),
            "wq": _w((lambda *s: torch.randn(*s, dtype=torch.bfloat16) * 0.05)(D, H * Dh)),
            "wk": _w((lambda *s: torch.randn(*s, dtype=torch.bfloat16) * 0.05)(D, Dh)),
            "wv": _w((lambda *s: torch.randn(*s, dtype=torch.bfloat16) * 0.05)(D, Dh)),
            "wo": _w((lambda *s: torch.randn(*s, dtype=torch.bfloat16) * 0.05)(H * Dh, D)),
        }
    _A_in = _A_setup()

    def _B_setup():
        B, S, D, F = 1, 2048, 640, 1728
        return {
            "x": _w((lambda *s: torch.randn(*s, dtype=torch.bfloat16) * 0.05)(B, S, D)),
            "w_gate": _w((lambda *s: torch.randn(*s, dtype=torch.bfloat16) * 0.05)(D, F)),
            "w_up": _w((lambda *s: torch.randn(*s, dtype=torch.bfloat16) * 0.05)(D, F)),
            "w_down": _w((lambda *s: torch.randn(*s, dtype=torch.bfloat16) * 0.05)(F, D)),
        }
    _B_in = _B_setup()

    return {
        "A_x": _A_in["x"],
        "A_wq": _A_in["wq"],
        "A_wk": _A_in["wk"],
        "A_wv": _A_in["wv"],
        "A_wo": _A_in["wo"],
        "B_x": _B_in["x"],
        "B_w_gate": _B_in["w_gate"],
        "B_w_up": _B_in["w_up"],
        "B_w_down": _B_in["w_down"],
    }

def reference(A_x, A_wq, A_wk, A_wv, A_wo, B_x, B_w_gate, B_w_up, B_w_down):
    def _A_ref(x, wq, wk, wv, wo):
        B, S, D = x.shape
        H = 32
        Dh = D // H
        q = (lambda x, *d: x.permute(*d))((x @ wq).reshape(B, S, H, Dh), 0, 2, 1, 3)
        k = x @ wk
        v = x @ wv
        scores = torch.einsum("bhqd,bkd->bhqk", q, k) * (Dh ** -0.5)
        p = _softmax(scores, axis=-1)
        o = torch.einsum("bhqk,bkd->bhqd", p, v)
        return (lambda x, *d: x.permute(*d))(o, 0, 2, 1, 3).reshape(B, S, H * Dh) @ wo

    def _B_ref(x, w_gate, w_up, w_down):
        g = _silu(x @ w_gate)
        u = x @ w_up
        return (g * u) @ w_down

    x = A_x
    xn = _layernorm(x, axis=-1)
    s = _A_ref(xn, A_wq, A_wk, A_wv, A_wo)
    g = _silu(_B_ref(xn, B_w_gate, B_w_up, B_w_down))
    return x + s * g
```

```asm
; @launch grid=(512,1,1) block=(512,1,1) lds=81920
.amdgcn_target "amdgcn-amd-amdhsa--gfx950"
.text
.globl recurrent_scan__grouped_kv_mqa__swiglu_ffn__prompt_kernel
.p2align 8
.type recurrent_scan__grouped_kv_mqa__swiglu_ffn__prompt_kernel,@function
recurrent_scan__grouped_kv_mqa__swiglu_ffn__prompt_kernel:
    s_cmp_ge_u32 s2, 512
    s_cbranch_scc0 M_GO
    s_endpgm
M_GO:
    s_load_dwordx4 s[36:39], s[0:1], 0
    s_load_dwordx4 s[40:43], s[0:1], 16
    s_load_dwordx2 s[44:45], s[0:1], 32
    s_load_dwordx4 s[48:51], s[0:1], 48
    s_load_dwordx4 s[52:55], s[0:1], 64
    s_load_dwordx4 s[56:59], s[0:1], 80
    s_memrealtime s[68:69]
    v_lshrrev_b32 v4, 6, v0
    v_and_b32 v1, 63, v0
    v_readfirstlane_b32 s3, v4
    v_lshlrev_b32 v2, 4, v1
    v_mov_b32 v3, 0
    s_and_b32 s28, s2, 255
    s_and_b32 s31, s2, 7
    s_lshr_b32 s32, s28, 3
    s_lshl_b32 s29, s31, 2
    s_and_b32 s62, s32, 3
    s_add_u32 s29, s29, s62
    s_lshr_b32 s30, s28, 5
    s_mov_b32 s34, 0xfffff
    s_mov_b32 s35, 0xfffff
    v_lshrrev_b32 v4, 4, v1
    s_and_b32 s60, s3, 1
    s_lshl_b32 s60, s60, 2
    v_add_u32 v4, s60, v4
    v_and_b32 v5, 7, v1
    v_xor_b32 v4, v4, v5
    v_lshrrev_b32 v5, 3, v1
    v_mul_u32_u24 v5, 1280, v5
    v_lshl_add_u32 v8, v4, 4, v5
    s_cmp_lt_u32 s2, 256
    s_waitcnt lgkmcnt(0)
    s_mov_b32 s8, s58
    s_mov_b32 s9, s59
    s_mov_b32 s10, 0x1400000
    s_mov_b32 s11, 0x20000
    s_mov_b32 s12, s36
    s_mov_b32 s13, s37
    s_mov_b32 s14, 0x280000
    s_mov_b32 s15, 0x20000
    s_mov_b32 s24, s56
    s_mov_b32 s25, s57
    s_mov_b32 s26, 0x100
    s_mov_b32 s27, 0x20000
    s_cbranch_scc0 ROLE_F
ROLE_A:
    s_or_b32 s62, s28, s3
    s_cmp_lg_u32 s62, 0
    s_cbranch_scc1 M_NT
    s_or_b32 s68, s68, 1
    v_mov_b32 v4, s68
    v_mov_b32 v5, 0
    s_mov_b64 exec, 1
    buffer_store_dword v4, v5, s[24:27], 0 offen sc1
    s_mov_b64 exec, -1
M_NT:
    s_cmp_lt_u32 s30, 4
    s_cbranch_scc0 AUX_2
    s_setprio 3
    s_lshr_b32 s80, s32, 3
    s_cmp_eq_u32 s80, 0
    s_cselect_b32 s4, s40, s42
    s_cselect_b32 s5, s41, s43
    s_mov_b32 s6, 25600
    s_mov_b32 s7, 0x20000
    s_bfe_u32 s60, s32, 0x10002
    s_lshl_b32 s81, s29, 1
    s_add_u32 s81, s81, s60
    s_mul_i32 s60, s81, 40960
    s_lshl_b32 s61, s3, 10
    v_add_u32 v4, 0, v0
    v_mul_u32_u24 v5, 3277, v4
    v_lshrrev_b32 v5, 18, v5
    v_mul_u32_u24 v6, 80, v5
    v_sub_u32 v4, v4, v6
    v_and_b32 v6, 15, v5
    v_xor_b32 v4, v4, v6
    v_and_b32 v6, 19, v5
    v_bfe_u32 v7, v5, 2, 1
    v_lshl_add_u32 v6, v7, 3, v6
    v_bfe_u32 v7, v5, 3, 1
    v_lshl_add_u32 v6, v7, 2, v6
    v_mul_u32_u24 v6, 1280, v6
    s_add_u32 m0, s61, 0
    v_lshl_add_u32 v4, v4, 4, v6
    buffer_load_dwordx4 v4, s[12:15], s60 offen lds
    v_add_u32 v4, 512, v0
    v_mul_u32_u24 v5, 3277, v4
    v_lshrrev_b32 v5, 18, v5
    v_mul_u32_u24 v6, 80, v5
    v_sub_u32 v4, v4, v6
    v_and_b32 v6, 15, v5
    v_xor_b32 v4, v4, v6
    v_and_b32 v6, 19, v5
    v_bfe_u32 v7, v5, 2, 1
    v_lshl_add_u32 v6, v7, 3, v6
    v_bfe_u32 v7, v5, 3, 1
    v_lshl_add_u32 v6, v7, 2, v6
    v_mul_u32_u24 v6, 1280, v6
    s_add_u32 m0, s61, 8192
    v_lshl_add_u32 v4, v4, 4, v6
    buffer_load_dwordx4 v4, s[12:15], s60 offen lds
    v_add_u32 v4, 1024, v0
    v_mul_u32_u24 v5, 3277, v4
    v_lshrrev_b32 v5, 18, v5
    v_mul_u32_u24 v6, 80, v5
    v_sub_u32 v4, v4, v6
    v_and_b32 v6, 15, v5
    v_xor_b32 v4, v4, v6
    v_and_b32 v6, 19, v5
    v_bfe_u32 v7, v5, 2, 1
    v_lshl_add_u32 v6, v7, 3, v6
    v_bfe_u32 v7, v5, 3, 1
    v_lshl_add_u32 v6, v7, 2, v6
    v_mul_u32_u24 v6, 1280, v6
    s_add_u32 m0, s61, 16384
    v_lshl_add_u32 v4, v4, 4, v6
    buffer_load_dwordx4 v4, s[12:15], s60 offen lds
    v_add_u32 v4, 1536, v0
    v_mul_u32_u24 v5, 3277, v4
    v_lshrrev_b32 v5, 18, v5
    v_mul_u32_u24 v6, 80, v5
    v_sub_u32 v4, v4, v6
    v_and_b32 v6, 15, v5
    v_xor_b32 v4, v4, v6
    v_and_b32 v6, 19, v5
    v_bfe_u32 v7, v5, 2, 1
    v_lshl_add_u32 v6, v7, 3, v6
    v_bfe_u32 v7, v5, 3, 1
    v_lshl_add_u32 v6, v7, 2, v6
    v_mul_u32_u24 v6, 1280, v6
    s_add_u32 m0, s61, 24576
    v_lshl_add_u32 v4, v4, 4, v6
    buffer_load_dwordx4 v4, s[12:15], s60 offen lds
    v_add_u32 v4, 2048, v0
    v_mul_u32_u24 v5, 3277, v4
    v_lshrrev_b32 v5, 18, v5
    v_mul_u32_u24 v6, 80, v5
    v_sub_u32 v4, v4, v6
    v_and_b32 v6, 15, v5
    v_xor_b32 v4, v4, v6
    v_and_b32 v6, 19, v5
    v_bfe_u32 v7, v5, 2, 1
    v_lshl_add_u32 v6, v7, 3, v6
    v_bfe_u32 v7, v5, 3, 1
    v_lshl_add_u32 v6, v7, 2, v6
    v_mul_u32_u24 v6, 1280, v6
    s_add_u32 m0, s61, 32768
    v_lshl_add_u32 v4, v4, 4, v6
    buffer_load_dwordx4 v4, s[12:15], s60 offen lds
    s_add_u32 m0, s61, 40960
    s_add_u32 s62, s61, 0
    buffer_load_dwordx4 v2, s[4:7], s62 offen lds
    s_add_u32 m0, s61, 49152
    s_add_u32 s62, s61, 8192
    buffer_load_dwordx4 v2, s[4:7], s62 offen lds
    s_add_u32 m0, s61, 57344
    s_add_u32 s62, s61, 16384
    buffer_load_dwordx4 v2, s[4:7], s62 offen lds
    s_cmp_lg_u32 s3, 0
    s_cbranch_scc1 KV_I
    s_add_u32 m0, s61, 65536
    s_add_u32 s62, s61, 24576
    buffer_load_dwordx4 v2, s[4:7], s62 offen lds
KV_I:
    s_lshr_b32 s60, s32, 2
    s_lshl_b32 s82, s29, 2
    s_add_u32 s82, s82, s60
    s_lshl_b32 s82, s82, 5
    s_add_u32 s82, s82, s3
    s_lshl_b32 s82, s82, 2
    s_add_u32 s82, s82, 0x2b0000
    v_and_b32 v123, 31, v1
    v_and_b32 v4, 19, v1
    v_bfe_u32 v5, v1, 2, 1
    v_lshl_add_u32 v4, v5, 3, v4
    v_bfe_u32 v5, v1, 3, 1
    v_lshl_add_u32 v120, v5, 2, v4
    v_lshrrev_b32 v124, 5, v1
    v_bfe_u32 v6, v1, 2, 2
    v_lshl_add_u32 v6, v124, 3, v6
    v_mul_u32_u24 v6, 40, v6
    v_bfe_u32 v7, v1, 4, 1
    v_lshl_add_u32 v6, v7, 5, v6
    s_mul_i32 s60, s3, 3200
    s_add_u32 s60, s60, 40960
    s_sub_u32 s61, 4, s80
    s_add_u32 s62, s80, 3
    v_and_b32 v7, 1, v1
    v_lshlrev_b32 v7, s61, v7
    v_add3_u32 v6, v6, v7, s60
    v_bfe_u32 v7, v1, 1, 1
    v_lshlrev_b32 v7, s62, v7
    v_add_u32 v121, v6, v7
    v_and_b32 v6, 15, v1
    v_xor_b32 v6, v6, v124
    v_mul_u32_u24 v7, 1280, v123
    s_mul_i32 s60, s3, 10
    v_xor_b32 v4, s60, v6
    s_add_u32 s60, s60, 2
    v_lshl_add_u32 v80, v4, 4, v7
    v_xor_b32 v4, s60, v6
    s_add_u32 s60, s60, 2
    v_lshl_add_u32 v81, v4, 4, v7
    v_xor_b32 v4, s60, v6
    s_add_u32 s60, s60, 2
    v_lshl_add_u32 v82, v4, 4, v7
    v_xor_b32 v4, s60, v6
    s_add_u32 s60, s60, 2
    v_lshl_add_u32 v83, v4, 4, v7
    v_xor_b32 v4, s60, v6
    s_add_u32 s60, s60, 2
    v_lshl_add_u32 v84, v4, 4, v7
    v_mov_b32 v122, 0x3f803f80
    v_mov_b32 v88, 0
    v_mov_b32 v89, 0
    v_mov_b32 v90, 0
    v_mov_b32 v91, 0
    v_mov_b32 v92, 0
    v_mov_b32 v93, 0
    s_waitcnt vmcnt(0)
    s_barrier
    ds_read_b128 v[24:27], v80
    ds_read_b64_tr_b16 v[44:45], v121 offset:0
    ds_read_b64_tr_b16 v[46:47], v121 offset:160
    ds_read_b128 v[28:31], v81
    ds_read_b64_tr_b16 v[48:49], v121 offset:640
    ds_read_b64_tr_b16 v[50:51], v121 offset:800
    ds_read_b128 v[32:35], v82
    ds_read_b64_tr_b16 v[52:53], v121 offset:1280
    ds_read_b64_tr_b16 v[54:55], v121 offset:1440
    ds_read_b128 v[36:39], v83
    ds_read_b64_tr_b16 v[56:57], v121 offset:1920
    ds_read_b64_tr_b16 v[58:59], v121 offset:2080
    ds_read_b128 v[40:43], v84
    ds_read_b64_tr_b16 v[60:61], v121 offset:2560
    ds_read_b64_tr_b16 v[62:63], v121 offset:2720
    v_mov_b32 v7, 0
    buffer_load_dword v3, v7, s[24:27], 0 offen sc1
    s_waitcnt lgkmcnt(0)
    v_dot2c_f32_bf16 v88, v122, v24
    v_dot2c_f32_bf16 v89, v24, v24
    v_dot2c_f32_bf16 v90, v122, v44
    v_dot2c_f32_bf16 v91, v122, v25
    v_dot2c_f32_bf16 v92, v25, v25
    v_dot2c_f32_bf16 v93, v122, v45
    v_dot2c_f32_bf16 v88, v122, v26
    v_dot2c_f32_bf16 v89, v26, v26
    v_dot2c_f32_bf16 v90, v122, v46
    v_dot2c_f32_bf16 v91, v122, v27
    v_dot2c_f32_bf16 v92, v27, v27
    v_dot2c_f32_bf16 v93, v122, v47
    v_dot2c_f32_bf16 v88, v122, v28
    v_dot2c_f32_bf16 v89, v28, v28
    v_dot2c_f32_bf16 v90, v122, v48
    v_dot2c_f32_bf16 v91, v122, v29
    v_dot2c_f32_bf16 v92, v29, v29
    v_dot2c_f32_bf16 v93, v122, v49
    v_dot2c_f32_bf16 v88, v122, v30
    v_dot2c_f32_bf16 v89, v30, v30
    v_dot2c_f32_bf16 v90, v122, v50
    v_dot2c_f32_bf16 v91, v122, v31
    v_dot2c_f32_bf16 v92, v31, v31
    v_dot2c_f32_bf16 v93, v122, v51
    v_dot2c_f32_bf16 v88, v122, v32
    v_dot2c_f32_bf16 v89, v32, v32
    v_dot2c_f32_bf16 v90, v122, v52
    v_dot2c_f32_bf16 v91, v122, v33
    v_dot2c_f32_bf16 v92, v33, v33
    v_dot2c_f32_bf16 v93, v122, v53
    v_dot2c_f32_bf16 v88, v122, v34
    v_dot2c_f32_bf16 v89, v34, v34
    v_dot2c_f32_bf16 v90, v122, v54
    v_dot2c_f32_bf16 v91, v122, v35
    v_dot2c_f32_bf16 v92, v35, v35
    v_dot2c_f32_bf16 v93, v122, v55
    v_dot2c_f32_bf16 v88, v122, v36
    v_dot2c_f32_bf16 v89, v36, v36
    v_dot2c_f32_bf16 v90, v122, v56
    v_dot2c_f32_bf16 v91, v122, v37
    v_dot2c_f32_bf16 v92, v37, v37
    v_dot2c_f32_bf16 v93, v122, v57
    v_dot2c_f32_bf16 v88, v122, v38
    v_dot2c_f32_bf16 v89, v38, v38
    v_dot2c_f32_bf16 v90, v122, v58
    v_dot2c_f32_bf16 v91, v122, v39
    v_dot2c_f32_bf16 v92, v39, v39
    v_dot2c_f32_bf16 v93, v122, v59
    v_dot2c_f32_bf16 v88, v122, v40
    v_dot2c_f32_bf16 v89, v40, v40
    v_dot2c_f32_bf16 v90, v122, v60
    v_dot2c_f32_bf16 v91, v122, v41
    v_dot2c_f32_bf16 v92, v41, v41
    v_dot2c_f32_bf16 v93, v122, v61
    v_dot2c_f32_bf16 v88, v122, v42
    v_dot2c_f32_bf16 v89, v42, v42
    v_dot2c_f32_bf16 v90, v122, v62
    v_dot2c_f32_bf16 v91, v122, v43
    v_dot2c_f32_bf16 v92, v43, v43
    v_dot2c_f32_bf16 v93, v122, v63
    s_cmp_eq_u32 s80, 0
    s_cbranch_scc0 KV_MV
    v_mfma_f32_32x32x16_bf16 v[64:79], v[44:47], v[24:27], 0
    v_mfma_f32_32x32x16_bf16 v[64:79], v[48:51], v[28:31], v[64:79]
    v_mfma_f32_32x32x16_bf16 v[64:79], v[52:55], v[32:35], v[64:79]
    v_mfma_f32_32x32x16_bf16 v[64:79], v[56:59], v[36:39], v[64:79]
    v_mfma_f32_32x32x16_bf16 v[64:79], v[60:63], v[40:43], v[64:79]
    s_branch KV_MD
KV_MV:
    v_mfma_f32_32x32x16_bf16 v[64:79], v[24:27], v[44:47], 0
    v_mfma_f32_32x32x16_bf16 v[64:79], v[28:31], v[48:51], v[64:79]
    v_mfma_f32_32x32x16_bf16 v[64:79], v[32:35], v[52:55], v[64:79]
    v_mfma_f32_32x32x16_bf16 v[64:79], v[36:39], v[56:59], v[64:79]
    v_mfma_f32_32x32x16_bf16 v[64:79], v[40:43], v[60:63], v[64:79]
KV_MD:
    s_barrier
    v_add_f32 v20, v88, v91
    v_add_f32 v21, v89, v92
    v_add_f32 v22, v90, v93
    v_mov_b32 v80, v20
    v_mov_b32 v81, v21
    v_mov_b32 v82, v22
    s_nop 1
    v_permlane32_swap_b32 v80, v20
    v_permlane32_swap_b32 v81, v21
    v_permlane32_swap_b32 v82, v22
    s_nop 1
    v_add_f32 v20, v80, v20
    v_add_f32 v21, v81, v21
    v_add_f32 v22, v82, v22
    s_lshl_b32 s60, s3, 8
    v_lshl_add_u32 v4, v123, 3, s60
    ds_write_b64 v4, v[20:21] offset:16384
    s_lshl_b32 s60, s3, 7
    v_lshl_add_u32 v4, v123, 2, s60
    ds_write_b32 v4, v22 offset:18432
    s_lshl_b32 s60, s3, 12
    s_add_u32 s60, s60, 49152
    v_add_u32 v4, s60, v2
    ds_write_b128 v4, v[64:67] offset:0
    ds_write_b128 v4, v[68:71] offset:1024
    ds_write_b128 v4, v[72:75] offset:2048
    ds_write_b128 v4, v[76:79] offset:3072
    s_waitcnt lgkmcnt(0)
    s_barrier
    s_cmp_ge_u32 s3, 4
    s_cbranch_scc1 AUX_RL
    s_lshl_b32 s60, s3, 10
    s_add_u32 s60, s60, 49152
    v_add_u32 v4, s60, v2
    ds_read_b128 v[24:27], v4 offset:0
    ds_read_b128 v[28:31], v4 offset:4096
    ds_read_b128 v[32:35], v4 offset:8192
    ds_read_b128 v[36:39], v4 offset:12288
    ds_read_b128 v[40:43], v4 offset:16384
    ds_read_b128 v[44:47], v4 offset:20480
    ds_read_b128 v[48:51], v4 offset:24576
    ds_read_b128 v[52:55], v4 offset:28672
    s_mul_i32 s63, s81, 2560
    s_add_u32 s63, s63, 0x280000
    s_cmp_eq_u32 s80, 0
    s_cbranch_scc0 KV_V
    v_lshlrev_b32 v4, 3, v123
    s_waitcnt lgkmcnt(4)
    ds_read_b64 v[56:57], v4 offset:16384
    ds_read_b64 v[58:59], v4 offset:16640
    ds_read_b64 v[60:61], v4 offset:16896
    ds_read_b64 v[62:63], v4 offset:17152
    ds_read_b64 v[64:65], v4 offset:17408
    ds_read_b64 v[66:67], v4 offset:17664
    ds_read_b64 v[68:69], v4 offset:17920
    ds_read_b64 v[70:71], v4 offset:18176
    s_lshl_b32 s60, s3, 5
    v_lshl_add_u32 v4, v124, 4, s60
    s_waitcnt lgkmcnt(4)
    ds_read_b128 v[72:75], v4 offset:18432
    ds_read_b128 v[76:79], v4 offset:18560
    ds_read_b128 v[80:83], v4 offset:18688
    ds_read_b128 v[84:87], v4 offset:18816
    ds_read_b128 v[88:91], v4 offset:18944
    ds_read_b128 v[92:95], v4 offset:19072
    ds_read_b128 v[96:99], v4 offset:19200
    ds_read_b128 v[100:103], v4 offset:19328
    v_add_f32 v24, v24, v28
    v_add_f32 v25, v25, v29
    v_add_f32 v26, v26, v30
    v_add_f32 v27, v27, v31
    v_add_f32 v32, v32, v36
    v_add_f32 v33, v33, v37
    v_add_f32 v34, v34, v38
    v_add_f32 v35, v35, v39
    v_add_f32 v40, v40, v44
    v_add_f32 v41, v41, v45
    v_add_f32 v42, v42, v46
    v_add_f32 v43, v43, v47
    v_add_f32 v48, v48, v52
    v_add_f32 v49, v49, v53
    v_add_f32 v50, v50, v54
    v_add_f32 v51, v51, v55
    v_add_f32 v24, v24, v32
    v_add_f32 v25, v25, v33
    v_add_f32 v26, v26, v34
    v_add_f32 v27, v27, v35
    v_add_f32 v40, v40, v48
    v_add_f32 v41, v41, v49
    v_add_f32 v42, v42, v50
    v_add_f32 v43, v43, v51
    v_add_f32 v24, v24, v40
    v_add_f32 v25, v25, v41
    v_add_f32 v26, v26, v42
    v_add_f32 v27, v27, v43
    s_waitcnt lgkmcnt(8)
    v_add_f32 v56, v56, v58
    v_add_f32 v57, v57, v59
    v_add_f32 v60, v60, v62
    v_add_f32 v61, v61, v63
    v_add_f32 v64, v64, v66
    v_add_f32 v65, v65, v67
    v_add_f32 v68, v68, v70
    v_add_f32 v69, v69, v71
    v_add_f32 v56, v56, v60
    v_add_f32 v57, v57, v61
    v_add_f32 v64, v64, v68
    v_add_f32 v65, v65, v69
    v_add_f32 v56, v56, v64
    v_add_f32 v57, v57, v65
    v_mul_f32 v20, 0xbacccccd, v56
    v_mul_f32 v57, 0x3acccccd, v57
    v_fma_f32 v57, -v20, v20, v57
    v_max_f32 v57, 0, v57
    v_add_f32 v57, 0x3727c5ac, v57
    v_rsq_f32 v21, v57
    s_nop 0
    v_lshlrev_b32 v6, 3, v120
    s_cmp_eq_u32 s3, 3
    s_cbranch_scc0 KV_K1
    s_lshl_b32 s60, s81, 8
    s_add_u32 s60, s60, 0x2a9000
    s_mov_b32 exec_hi, 0
    buffer_store_dwordx2 v[20:21], v6, s[8:11], s60 offen sc1
    s_mov_b64 exec, -1
    s_branch KV_FLAG
KV_K1:
    s_waitcnt lgkmcnt(0)
    v_add_f32 v72, v72, v76
    v_add_f32 v73, v73, v77
    v_add_f32 v74, v74, v78
    v_add_f32 v75, v75, v79
    v_add_f32 v80, v80, v84
    v_add_f32 v81, v81, v85
    v_add_f32 v82, v82, v86
    v_add_f32 v83, v83, v87
    v_add_f32 v88, v88, v92
    v_add_f32 v89, v89, v93
    v_add_f32 v90, v90, v94
    v_add_f32 v91, v91, v95
    v_add_f32 v96, v96, v100
    v_add_f32 v97, v97, v101
    v_add_f32 v98, v98, v102
    v_add_f32 v99, v99, v103
    v_add_f32 v72, v72, v80
    v_add_f32 v73, v73, v81
    v_add_f32 v74, v74, v82
    v_add_f32 v75, v75, v83
    v_add_f32 v88, v88, v96
    v_add_f32 v89, v89, v97
    v_add_f32 v90, v90, v98
    v_add_f32 v91, v91, v99
    v_add_f32 v72, v72, v88
    v_add_f32 v73, v73, v89
    v_add_f32 v74, v74, v90
    v_add_f32 v75, v75, v91
    v_fmac_f32 v24, v20, v72
    v_fmac_f32 v25, v20, v73
    v_fmac_f32 v26, v20, v74
    v_fmac_f32 v27, v20, v75
    v_mul_f32 v24, v21, v24
    v_mul_f32 v25, v21, v25
    v_mul_f32 v26, v21, v26
    v_mul_f32 v27, v21, v27
    v_cvt_pk_bf16_f32 v56, v24, v25
    v_cvt_pk_bf16_f32 v57, v26, v27
    v_mov_b32 v7, 0
    s_cmp_eq_u32 s3, 2
    s_cbranch_scc1 KV_K2
    v_lshlrev_b32 v4, 9, v124
    v_lshl_add_u32 v6, v120, 4, v4
    s_lshl_b32 s60, s3, 3
    s_add_u32 s63, s63, s60
    s_branch KV_K3
KV_K2:
    s_add_u32 s63, s63, 1024
    s_mov_b32 exec_hi, 0
KV_K3:
    buffer_store_dwordx2 v[56:57], v6, s[8:11], s63 offen sc1
    v_fmac_f32 v7, v24, v24
    v_fmac_f32 v7, v25, v25
    v_fmac_f32 v7, v26, v26
    v_fmac_f32 v7, v27, v27
    s_mov_b64 exec, -1
    v_mov_b32 v72, v7
    s_nop 1
    v_permlane32_swap_b32 v72, v7
    s_nop 1
    v_add_f32 v7, v72, v7
    s_nop 1
    v_max_f32_dpp v7, v7, v7 quad_perm:[1,0,3,2] row_mask:0xf bank_mask:0xf
    s_nop 1
    v_max_f32_dpp v7, v7, v7 quad_perm:[2,3,0,1] row_mask:0xf bank_mask:0xf
    s_nop 1
    v_max_f32_dpp v7, v7, v7 row_half_mirror row_mask:0xf bank_mask:0xf
    s_nop 1
    v_max_f32_dpp v7, v7, v7 row_mirror row_mask:0xf bank_mask:0xf
    s_nop 1
    v_readlane_b32 s60, v7, 0
    v_readlane_b32 s61, v7, 16
    s_lshl_b32 s62, s81, 2
    s_add_u32 s62, s62, s3
    s_lshl_b32 s62, s62, 2
    s_add_u32 s62, s62, 0x2a8000
    s_max_u32 s60, s60, s61
    v_mov_b32 v7, s60
    v_mov_b32 v4, 0
    s_mov_b64 exec, 1
    buffer_store_dword v7, v4, s[8:11], s62 offen sc1
    s_mov_b64 exec, -1
    s_branch KV_FLAG
KV_V:
    s_lshl_b32 s60, s3, 6
    v_lshl_add_u32 v4, v124, 5, s60
    s_waitcnt lgkmcnt(4)
    ds_read_b128 v[56:59], v4 offset:16384
    ds_read_b128 v[60:63], v4 offset:16400
    ds_read_b128 v[64:67], v4 offset:16640
    ds_read_b128 v[68:71], v4 offset:16656
    ds_read_b128 v[72:75], v4 offset:16896
    ds_read_b128 v[76:79], v4 offset:16912
    ds_read_b128 v[80:83], v4 offset:17152
    ds_read_b128 v[84:87], v4 offset:17168
    ds_read_b128 v[88:91], v4 offset:17408
    ds_read_b128 v[92:95], v4 offset:17424
    v_lshlrev_b32 v6, 2, v123
    s_waitcnt lgkmcnt(8)
    ds_read_b128 v[96:99], v4 offset:17664
    ds_read_b128 v[100:103], v4 offset:17680
    ds_read_b128 v[104:107], v4 offset:17920
    ds_read_b128 v[108:111], v4 offset:17936
    ds_read_b128 v[112:115], v4 offset:18176
    ds_read_b128 v[116:119], v4 offset:18192
    v_add_f32 v24, v24, v28
    v_add_f32 v25, v25, v29
    v_add_f32 v26, v26, v30
    v_add_f32 v27, v27, v31
    v_add_f32 v32, v32, v36
    v_add_f32 v33, v33, v37
    v_add_f32 v34, v34, v38
    v_add_f32 v35, v35, v39
    v_add_f32 v40, v40, v44
    v_add_f32 v41, v41, v45
    v_add_f32 v42, v42, v46
    v_add_f32 v43, v43, v47
    v_add_f32 v48, v48, v52
    v_add_f32 v49, v49, v53
    v_add_f32 v50, v50, v54
    v_add_f32 v51, v51, v55
    v_add_f32 v24, v24, v32
    v_add_f32 v25, v25, v33
    v_add_f32 v26, v26, v34
    v_add_f32 v27, v27, v35
    v_add_f32 v40, v40, v48
    v_add_f32 v41, v41, v49
    v_add_f32 v42, v42, v50
    v_add_f32 v43, v43, v51
    v_add_f32 v24, v24, v40
    v_add_f32 v25, v25, v41
    v_add_f32 v26, v26, v42
    v_add_f32 v27, v27, v43
    s_waitcnt lgkmcnt(6)
    ds_read_b32 v28, v6 offset:18432
    ds_read_b32 v29, v6 offset:18560
    ds_read_b32 v30, v6 offset:18688
    ds_read_b32 v31, v6 offset:18816
    ds_read_b32 v32, v6 offset:18944
    ds_read_b32 v33, v6 offset:19072
    ds_read_b32 v34, v6 offset:19200
    ds_read_b32 v35, v6 offset:19328
    s_waitcnt lgkmcnt(8)
    v_add_f32 v56, v56, v64
    v_add_f32 v57, v57, v65
    v_add_f32 v58, v58, v66
    v_add_f32 v59, v59, v67
    v_add_f32 v60, v60, v68
    v_add_f32 v61, v61, v69
    v_add_f32 v62, v62, v70
    v_add_f32 v63, v63, v71
    v_add_f32 v72, v72, v80
    v_add_f32 v73, v73, v81
    v_add_f32 v74, v74, v82
    v_add_f32 v75, v75, v83
    v_add_f32 v76, v76, v84
    v_add_f32 v77, v77, v85
    v_add_f32 v78, v78, v86
    v_add_f32 v79, v79, v87
    v_add_f32 v88, v88, v96
    v_add_f32 v89, v89, v97
    v_add_f32 v90, v90, v98
    v_add_f32 v91, v91, v99
    v_add_f32 v92, v92, v100
    v_add_f32 v93, v93, v101
    v_add_f32 v94, v94, v102
    v_add_f32 v95, v95, v103
    v_add_f32 v104, v104, v112
    v_add_f32 v105, v105, v113
    v_add_f32 v106, v106, v114
    v_add_f32 v107, v107, v115
    v_add_f32 v108, v108, v116
    v_add_f32 v109, v109, v117
    v_add_f32 v110, v110, v118
    v_add_f32 v111, v111, v119
    v_add_f32 v56, v56, v72
    v_add_f32 v57, v57, v73
    v_add_f32 v58, v58, v74
    v_add_f32 v59, v59, v75
    v_add_f32 v60, v60, v76
    v_add_f32 v61, v61, v77
    v_add_f32 v62, v62, v78
    v_add_f32 v63, v63, v79
    v_add_f32 v88, v88, v104
    v_add_f32 v89, v89, v105
    v_add_f32 v90, v90, v106
    v_add_f32 v91, v91, v107
    v_add_f32 v92, v92, v108
    v_add_f32 v93, v93, v109
    v_add_f32 v94, v94, v110
    v_add_f32 v95, v95, v111
    v_add_f32 v56, v56, v88
    v_add_f32 v57, v57, v89
    v_add_f32 v58, v58, v90
    v_add_f32 v59, v59, v91
    v_add_f32 v60, v60, v92
    v_add_f32 v61, v61, v93
    v_add_f32 v62, v62, v94
    v_add_f32 v63, v63, v95
    v_mul_f32 v64, 0xbacccccd, v56
    v_mul_f32 v57, 0x3acccccd, v57
    v_fma_f32 v57, -v64, v64, v57
    v_max_f32 v57, 0, v57
    v_add_f32 v57, 0x3727c5ac, v57
    v_rsq_f32 v65, v57
    s_nop 0
    v_mul_f32 v66, 0xbacccccd, v58
    v_mul_f32 v59, 0x3acccccd, v59
    v_fma_f32 v59, -v66, v66, v59
    v_max_f32 v59, 0, v59
    v_add_f32 v59, 0x3727c5ac, v59
    v_rsq_f32 v67, v59
    s_nop 0
    v_mul_f32 v68, 0xbacccccd, v60
    v_mul_f32 v61, 0x3acccccd, v61
    v_fma_f32 v61, -v68, v68, v61
    v_max_f32 v61, 0, v61
    v_add_f32 v61, 0x3727c5ac, v61
    v_rsq_f32 v69, v61
    s_nop 0
    v_mul_f32 v70, 0xbacccccd, v62
    v_mul_f32 v63, 0x3acccccd, v63
    v_fma_f32 v63, -v70, v70, v63
    v_max_f32 v63, 0, v63
    v_add_f32 v63, 0x3727c5ac, v63
    v_rsq_f32 v71, v63
    s_nop 0
    s_waitcnt lgkmcnt(0)
    v_add_f32 v28, v28, v29
    v_add_f32 v30, v30, v31
    v_add_f32 v32, v32, v33
    v_add_f32 v34, v34, v35
    v_add_f32 v28, v28, v30
    v_add_f32 v32, v32, v34
    v_add_f32 v28, v28, v32
    v_fmac_f32 v24, v28, v64
    v_fmac_f32 v25, v28, v66
    v_fmac_f32 v26, v28, v68
    v_fmac_f32 v27, v28, v70
    v_mul_f32 v24, v65, v24
    v_mul_f32 v25, v67, v25
    v_mul_f32 v26, v69, v26
    v_mul_f32 v27, v71, v27
    v_cvt_pk_bf16_f32 v30, v24, v25
    v_cvt_pk_bf16_f32 v31, v26, v27
    v_mul_u32_u24 v4, 320, v124
    v_lshl_add_u32 v4, v123, 4, v4
    s_lshr_b32 s60, s3, 1
    s_mul_i32 s60, s60, 640
    s_add_u32 s63, s63, s60
    s_and_b32 s60, s3, 1
    s_lshl_b32 s60, s60, 3
    s_add_u32 s63, s63, s60
    s_mov_b64 exec, s[34:35]
    buffer_store_dwordx2 v[30:31], v4, s[8:11], s63 offen offset:1280 sc1
    s_mov_b64 exec, -1
KV_FLAG:
    s_mov_b32 s85, s82
    s_waitcnt lgkmcnt(0)
    s_mov_b32 s66, 16384
    v_mov_b32 v4, 0
GL_1:
    s_waitcnt vmcnt(0)
    v_cmp_ne_u32 vcc, 0, v3
    s_nop 0
    s_cbranch_vccnz GK_2
    buffer_load_dword v3, v4, s[24:27], 0 offen sc1
    s_sub_u32 s66, s66, 1
    s_cmp_lg_u32 s66, 0
    s_cbranch_scc1 GL_1
GK_2:
    s_mov_b64 exec, 1
    buffer_store_dword v3, v4, s[8:11], s85 offen sc1
    s_mov_b64 exec, -1
    s_branch AUX_RL
A_GO:
    s_setprio 1
    s_and_b32 s70, s3, 1
    s_lshr_b32 s62, s3, 1
    s_lshl_b32 s71, s30, 2
    s_add_u32 s71, s71, s62
    v_and_b32 v4, 31, v1
    v_lshrrev_b32 v5, 5, v1
    v_mov_b32 v120, v2
    v_lshlrev_b32 v121, 3, v4
    v_mul_u32_u24 v122, 320, v5
    v_lshl_add_u32 v122, v4, 4, v122
    v_mov_b32 v123, v122
    v_mov_b32 v124, 0xdddddddd
    s_mul_i32 s60, s71, 20
    v_lshlrev_b32 v4, 4, v4
    v_lshl_add_u32 v6, v5, 3, s60
    v_lshrrev_b32 v7, 3, v6
    v_lshl_add_u32 v74, v7, 9, v4
    v_and_b32 v7, 4, v6
    v_lshl_add_u32 v74, v7, 1, v74
    v_lshl_add_u32 v6, v5, 3, s60
    v_add_u32 v6, 4, v6
    v_lshrrev_b32 v7, 3, v6
    v_lshl_add_u32 v75, v7, 9, v4
    v_and_b32 v7, 4, v6
    v_lshl_add_u32 v75, v7, 1, v75
    v_mov_b32 v6, s60
    v_add_u32 v6, 16, v6
    v_lshrrev_b32 v7, 3, v6
    v_lshl_add_u32 v76, v7, 9, v4
    v_and_b32 v7, 4, v6
    v_lshl_add_u32 v76, v7, 1, v76
    s_lshl_b32 s81, s29, 1
    s_add_u32 s81, s81, s70
    s_mul_i32 s81, s81, 40960
    v_and_b32 v6, 3, v1
    v_lshlrev_b32 v6, 5, v6
    v_min_u32 v6, 79, v6
    s_mul_i32 s61, s30, 80
    v_add_u32 v6, s61, v6
    v_lshrrev_b32 v7, 7, v6
    v_add_u32 v7, 27, v7
    v_lshrrev_b32 v77, 1, v7
    v_lshlrev_b32 v77, 7, v77
    v_and_b32 v7, 1, v7
    v_lshl_add_u32 v77, v7, 4, v77
    v_bfe_u32 v7, v6, 5, 1
    v_lshl_add_u32 v77, v7, 3, v77
    s_lshr_b32 s61, s29, 1
    s_lshl_b32 s61, s61, 11
    s_and_b32 s62, s29, 1
    s_lshl_b32 s62, s62, 2
    s_add_u32 s61, s61, s62
    s_add_u32 s61, s61, 0x2b4000
    v_add_u32 v77, s61, v77
    v_lshl_add_u32 v5, v5, 2, s60
    v_and_b32 v4, 15, v1
    v_lshlrev_b32 v4, 4, v4
    v_bfe_u32 v6, v1, 4, 1
    v_lshl_add_u32 v4, v6, 10, v4
    v_add_u32 v6, 0, v5
    v_lshrrev_b32 v7, 5, v6
    v_lshl_add_u32 v125, v7, 12, v4
    v_bfe_u32 v7, v6, 3, 2
    v_lshl_add_u32 v125, v7, 8, v125
    v_and_b32 v7, 7, v6
    v_lshl_add_u32 v125, v7, 1, v125
    v_add_u32 v6, 8, v5
    v_lshrrev_b32 v7, 5, v6
    v_lshl_add_u32 v126, v7, 12, v4
    v_bfe_u32 v7, v6, 3, 2
    v_lshl_add_u32 v126, v7, 8, v126
    v_and_b32 v7, 7, v6
    v_lshl_add_u32 v126, v7, 1, v126
    v_add_u32 v6, 16, v5
    v_lshrrev_b32 v7, 5, v6
    v_lshl_add_u32 v127, v7, 12, v4
    v_bfe_u32 v7, v6, 3, 2
    v_lshl_add_u32 v127, v7, 8, v127
    v_and_b32 v7, 7, v6
    v_lshl_add_u32 v127, v7, 1, v127
    s_mul_i32 s78, s29, 74
    s_add_u32 s78, s78, 54
    s_lshl_b32 s78, s78, 12
    s_lshl_b32 s61, s70, 11
    s_add_u32 s78, s78, s61
    s_add_u32 s78, s78, 0x600000
    s_lshl_b32 s79, s29, 10
    s_lshl_b32 s61, s30, 7
    s_add_u32 s79, s79, s61
    s_lshl_b32 s61, s3, 2
    s_add_u32 s79, s79, s61
    s_add_u32 s79, s79, 0x2bc000
    s_lshl_b32 s61, s29, 10
    s_add_u32 s61, s61, 0x2bc020
    v_and_b32 v72, 7, v1
    v_lshlrev_b32 v72, 7, v72
    v_add_u32 v72, s61, v72
    v_mov_b32 v112, 0
    v_mov_b32 v113, 0
    v_mov_b32 v114, 0
    v_mov_b32 v115, 0
    v_mov_b32 v116, 0
    v_mov_b32 v117, 0
    v_mov_b32 v118, 0
    v_mov_b32 v119, 0
    s_mov_b32 exec_lo, 0x11000000
    s_mov_b32 exec_hi, 0x11000000
    v_mov_b32 v112, 0x3f803f80
    v_mov_b32 v113, 0x3f803f80
    v_mov_b32 v114, 0x3f803f80
    v_mov_b32 v115, 0x3f803f80
    v_mov_b32 v116, 0x3f803f80
    v_mov_b32 v117, 0x3f803f80
    v_mov_b32 v118, 0x3f803f80
    v_mov_b32 v119, 0x3f803f80
    s_mov_b64 exec, -1
    v_mov_b32 v64, v112
    v_mov_b32 v65, v112
    v_mov_b32 v66, v112
    v_mov_b32 v67, v112
    v_mov_b32 v68, v112
    v_mov_b32 v69, v112
    v_mov_b32 v70, v112
    v_mov_b32 v71, v112
    v_mov_b32 v96, 0
    v_mov_b32 v97, 0
    v_mov_b32 v98, 0
    v_mov_b32 v99, 0
    v_mov_b32 v100, 0
    v_mov_b32 v101, 0
    v_mov_b32 v102, 0
    v_mov_b32 v103, 0
    v_mov_b32 v104, 0
    v_mov_b32 v105, 0
    v_mov_b32 v106, 0
    v_mov_b32 v107, 0
    v_mov_b32 v108, 0
    v_mov_b32 v109, 0
    v_mov_b32 v110, 0
    v_mov_b32 v111, 0
    v_mov_b32 v48, 0
    v_mov_b32 v49, 0
    v_mov_b32 v50, 0
    v_mov_b32 v51, 0
    v_mov_b32 v52, 0
    v_mov_b32 v53, 0
    v_mov_b32 v54, 0
    v_mov_b32 v55, 0
    v_mov_b32 v22, 0x3f803f80
    v_mov_b32 v62, 0x3f803f80
    v_mov_b32 v23, 0x00003f80
    v_mov_b32 v63, 0x00003f80
    v_mov_b32 v14, 0
    v_mov_b32 v15, 0
    v_lshlrev_b32 v4, 7, v1
    s_mov_b32 s61, 0x2b0000
    s_mov_b32 s62, 0x2b2000
    s_cmp_lg_u32 s3, 0
    s_cbranch_scc1 A_PP
    s_cmp_lt_u32 s30, 4
    s_cbranch_scc1 A_PP
    v_and_b32 v5, 0x180, v4
    s_lshl_b32 s63, s29, 9
    s_add_u32 s63, s63, 0x2b0000
    s_mov_b32 s60, 16384
PL_4:
    v_mov_b32 v7, 0
    buffer_load_dword v3, v7, s[24:27], 0 offen sc1
    buffer_load_dwordx4 v[24:27], v5, s[8:11], s63 offen sc1
    s_waitcnt vmcnt(0)
    v_cmp_eq_u32 vcc, 0, v3
    v_cmp_ne_u32 s[64:65], v3, v24
    s_or_b64 vcc, vcc, s[64:65]
    v_cmp_ne_u32 s[64:65], v3, v25
    s_or_b64 vcc, vcc, s[64:65]
    v_cmp_ne_u32 s[64:65], v3, v26
    s_or_b64 vcc, vcc, s[64:65]
    v_cmp_ne_u32 s[64:65], v3, v27
    s_or_b64 vcc, vcc, s[64:65]
    s_cbranch_scc0 PD_3
    s_sleep 40
    s_sub_u32 s60, s60, 1
    s_cmp_lg_u32 s60, 0
    s_cbranch_scc1 PL_4
PD_3:
A_PP:
    s_cmp_lg_u32 s3, 0
    s_cbranch_scc1 PD_5
    s_mov_b32 s60, 16384
PL_6:
    v_mov_b32 v7, 0
    buffer_load_dword v3, v7, s[24:27], 0 offen sc1
    buffer_load_dwordx4 v[24:27], v4, s[8:11], s61 offen sc1
    buffer_load_dwordx4 v[28:31], v4, s[8:11], s62 offen sc1
    s_waitcnt vmcnt(0)
    v_cmp_eq_u32 vcc, 0, v3
    v_cmp_ne_u32 s[64:65], v3, v24
    s_or_b64 vcc, vcc, s[64:65]
    v_cmp_ne_u32 s[64:65], v3, v25
    s_or_b64 vcc, vcc, s[64:65]
    v_cmp_ne_u32 s[64:65], v3, v26
    s_or_b64 vcc, vcc, s[64:65]
    v_cmp_ne_u32 s[64:65], v3, v27
    s_or_b64 vcc, vcc, s[64:65]
    v_cmp_ne_u32 s[64:65], v3, v28
    s_or_b64 vcc, vcc, s[64:65]
    v_cmp_ne_u32 s[64:65], v3, v29
    s_or_b64 vcc, vcc, s[64:65]
    v_cmp_ne_u32 s[64:65], v3, v30
    s_or_b64 vcc, vcc, s[64:65]
    v_cmp_ne_u32 s[64:65], v3, v31
    s_or_b64 vcc, vcc, s[64:65]
    s_cbranch_scc0 PD_5
    s_sleep 40
    s_sub_u32 s60, s60, 1
    s_cmp_lg_u32 s60, 0
    s_cbranch_scc1 PL_6
PD_5:
    s_barrier
    s_mov_b32 s60, 0x2a8000
    buffer_load_dwordx4 v[24:27], v2, s[8:11], s60 offen sc1
    s_lshl_b32 s73, s3, 10
    s_add_u32 s72, s73, 0x280000
    s_add_u32 m0, s73, 0
    s_add_u32 s60, s72, 0
    buffer_load_dwordx4 v2, s[8:11], s60 offen sc1 lds
    s_add_u32 m0, s73, 8192
    s_add_u32 s60, s72, 8192
    buffer_load_dwordx4 v2, s[8:11], s60 offen sc1 lds
    s_cmp_ge_u32 s3, 4
    s_cbranch_scc1 A2_DSa
    s_add_u32 m0, s73, 16384
    s_add_u32 s60, s72, 16384
    buffer_load_dwordx4 v2, s[8:11], s60 offen sc1 lds
A2_DSa:
    s_add_u32 s72, s72, 20480
    s_add_u32 s73, s73, 20480
    s_cmp_ge_u32 s73, 61440
    s_cbranch_scc0 A2_DWa
    s_sub_u32 s73, s73, 61440
A2_DWa:
    s_add_u32 m0, s73, 0
    s_add_u32 s60, s72, 0
    buffer_load_dwordx4 v2, s[8:11], s60 offen sc1 lds
    s_add_u32 m0, s73, 8192
    s_add_u32 s60, s72, 8192
    buffer_load_dwordx4 v2, s[8:11], s60 offen sc1 lds
    s_cmp_ge_u32 s3, 4
    s_cbranch_scc1 A2_DSb
    s_add_u32 m0, s73, 16384
    s_add_u32 s60, s72, 16384
    buffer_load_dwordx4 v2, s[8:11], s60 offen sc1 lds
A2_DSb:
    s_add_u32 s72, s72, 20480
    s_add_u32 s73, s73, 20480
    s_cmp_ge_u32 s73, 61440
    s_cbranch_scc0 A2_DWb
    s_sub_u32 s73, s73, 61440
A2_DWb:
    s_waitcnt vmcnt(0)
    s_barrier
    v_add_f32 v24, v24, v25
    v_add_f32 v24, v24, v26
    s_nop 1
    v_max_f32_dpp v24, v24, v24 quad_perm:[1,0,3,2] row_mask:0xf bank_mask:0xf
    s_nop 1
    v_max_f32_dpp v24, v24, v24 quad_perm:[2,3,0,1] row_mask:0xf bank_mask:0xf
    s_nop 1
    v_max_f32_dpp v24, v24, v24 row_half_mirror row_mask:0xf bank_mask:0xf
    s_nop 1
    v_max_f32_dpp v24, v24, v24 row_mirror row_mask:0xf bank_mask:0xf
    s_nop 0
    v_readlane_b32 s60, v24, 0
    v_readlane_b32 s61, v24, 16
    v_readlane_b32 s62, v24, 32
    v_readlane_b32 s63, v24, 48
    s_nop 3
    s_max_u32 s60, s60, s61
    s_max_u32 s62, s62, s63
    s_max_u32 s80, s60, s62
    v_mov_b32 v7, 0
    buffer_load_dword v3, v7, s[24:27], 0 offen sc1
    s_cmp_lg_u32 s3, 0
    s_cbranch_scc1 PD_7
    s_mov_b32 s60, 16384
PL_8:
    v_mov_b32 v7, 0
    buffer_load_dword v3, v7, s[24:27], 0 offen sc1
    buffer_load_dword v5, v77, s[8:11], 0 offen sc1
    s_waitcnt vmcnt(0)
    v_cmp_eq_u32 vcc, 0, v3
    v_cmp_ne_u32 s[64:65], v3, v5
    s_or_b64 vcc, vcc, s[64:65]
    s_cbranch_scc0 PD_7
    s_sleep 6
    s_sub_u32 s60, s60, 1
    s_cmp_lg_u32 s60, 0
    s_cbranch_scc1 PL_8
PD_7:
    s_barrier
    s_setprio 3
    buffer_load_dwordx2 v[8:9], v74, s[8:11], s81 offen sc1
    buffer_load_dwordx2 v[10:11], v75, s[8:11], s81 offen sc1
    buffer_load_dwordx2 v[12:13], v76, s[8:11], s81 offen sc1
    v_mov_b32 v6, 0
    s_waitcnt vmcnt(0)
    s_cmp_lg_u32 s3, 0
    s_cbranch_scc1 A_NS
    s_mov_b64 exec, 1
    buffer_store_dword v3, v6, s[8:11], s79 offen offset:36 sc1
    s_mov_b64 exec, -1
A_NS:
    s_mov_b32 exec_lo, 0
    v_mov_b32 v12, 0
    v_mov_b32 v13, 0
    s_mov_b64 exec, -1
    v_lshlrev_b32 v4, 16, v8
    v_and_b32 v5, 0xffff0000, v8
    v_fmac_f32 v6, v4, v4
    v_fmac_f32 v6, v5, v5
    v_lshlrev_b32 v4, 16, v9
    v_and_b32 v5, 0xffff0000, v9
    v_fmac_f32 v6, v4, v4
    v_fmac_f32 v6, v5, v5
    v_lshlrev_b32 v4, 16, v10
    v_and_b32 v5, 0xffff0000, v10
    v_fmac_f32 v6, v4, v4
    v_fmac_f32 v6, v5, v5
    v_lshlrev_b32 v4, 16, v11
    v_and_b32 v5, 0xffff0000, v11
    v_fmac_f32 v6, v4, v4
    v_fmac_f32 v6, v5, v5
    v_lshlrev_b32 v4, 16, v12
    v_and_b32 v5, 0xffff0000, v12
    v_fmac_f32 v6, v4, v4
    v_fmac_f32 v6, v5, v5
    v_lshlrev_b32 v4, 16, v13
    v_and_b32 v5, 0xffff0000, v13
    v_fmac_f32 v6, v4, v4
    v_fmac_f32 v6, v5, v5
    v_mov_b32 v7, v6
    s_nop 1
    v_permlane32_swap_b32 v7, v6
    s_nop 1
    v_add_f32 v6, v7, v6
    v_mul_f32 v6, s80, v6
    v_sqrt_f32 v6, v6
    v_mov_b32 v7, 0x42900000
    v_mul_f32 v6, 0x3f828f5c, v6
    v_cmp_nle_f32 vcc, v6, v7
    v_add_f32 v6, 0xc2400000, v6
    s_nop 0
    s_cbranch_vccnz A2_FB
A2_SETM:
    v_sub_f32 v6, 0, v6
    v_and_b32 v7, 0xffff0000, v6
    v_sub_f32 v6, v6, v7
    v_and_b32 v4, 0xffff0000, v6
    v_sub_f32 v6, v6, v4
    v_lshrrev_b32 v7, 16, v7
    s_mov_b32 exec_hi, 0
    v_or_b32 v14, v7, v4
    v_lshrrev_b32 v15, 16, v6
    s_mov_b64 exec, -1
    s_setprio 1
    ds_read_b128 v[56:59], v120 offset:0
    ds_read_b64 v[60:61], v121 offset:1024
    ds_read_b128 v[16:19], v120 offset:2560
    ds_read_b64 v[20:21], v121 offset:3584
    s_mov_b64 exec, s[34:35]
    ds_read_b128 v[112:115], v122 offset:1280
    s_mov_b64 exec, -1
    s_waitcnt lgkmcnt(3)
    v_mfma_f32_32x32x16_bf16 v[24:39], v[56:59], v[8:11], 0
    v_mfma_f32_32x32x16_bf16 v[24:39], v[60:63], v[12:15], v[24:39]
    s_mov_b32 s74, 0
    s_mov_b32 s76, 0
    s_nop 7
A2_LOOP:
    s_add_u32 s76, s76, 20480
    s_cmp_eq_u32 s76, 61440
    s_mov_b32 s75, 0x5000
    s_cmov_b32 s75, 0xffff6000
    s_cselect_b32 s76, 0, s76
    s_waitcnt lgkmcnt(0)
    ds_read_b128 v[56:59], v120 offset:5120
    v_smfmac_f32_32x32x32_bf16 v[96:111], v[116:119], v[48:55], v124
    ds_read_b64 v[60:61], v121 offset:6144
    v_exp_f32 v24, v24
    v_exp_f32 v25, v25
    v_exp_f32 v26, v26
    v_exp_f32 v27, v27
    v_mfma_f32_32x32x16_bf16 v[40:55], v[16:19], v[8:11], 0
    s_mov_b64 exec, s[34:35]
    ds_read_b128 v[68:71], v123 offset:1920
    ds_read_b128 v[64:67], v122 offset:3840
    s_mov_b64 exec, -1
    v_exp_f32 v28, v28
    v_exp_f32 v29, v29
    v_exp_f32 v30, v30
    v_exp_f32 v31, v31
    v_mfma_f32_32x32x16_bf16 v[40:55], v[20:23], v[12:15], v[40:55]
    v_exp_f32 v32, v32
    v_exp_f32 v33, v33
    v_exp_f32 v34, v34
    v_exp_f32 v35, v35
    v_smfmac_f32_32x32x32_bf16 v[96:111], v[112:115], v[24:31], v124
    v_exp_f32 v36, v36
    v_exp_f32 v37, v37
    v_exp_f32 v38, v38
    v_exp_f32 v39, v39
    s_waitcnt lgkmcnt(0)
    ds_read_b128 v[16:19], v120 offset:7680
    v_smfmac_f32_32x32x32_bf16 v[96:111], v[68:71], v[32:39], v124
    ds_read_b64 v[20:21], v121 offset:8704
    v_exp_f32 v40, v40
    v_exp_f32 v41, v41
    v_exp_f32 v42, v42
    v_exp_f32 v43, v43
    v_mfma_f32_32x32x16_bf16 v[24:39], v[56:59], v[8:11], 0
    s_mov_b64 exec, s[34:35]
    ds_read_b128 v[116:119], v123 offset:4480
    ds_read_b128 v[112:115], v122 offset:6400
    s_mov_b64 exec, -1
    v_exp_f32 v44, v44
    v_exp_f32 v45, v45
    v_exp_f32 v46, v46
    v_exp_f32 v47, v47
    v_mfma_f32_32x32x16_bf16 v[24:39], v[60:63], v[12:15], v[24:39]
    v_exp_f32 v48, v48
    v_exp_f32 v49, v49
    v_exp_f32 v50, v50
    v_exp_f32 v51, v51
    v_smfmac_f32_32x32x32_bf16 v[96:111], v[64:67], v[40:47], v124
    v_exp_f32 v52, v52
    v_exp_f32 v53, v53
    v_exp_f32 v54, v54
    v_exp_f32 v55, v55
    s_waitcnt lgkmcnt(0)
    ds_read_b128 v[56:59], v120 offset:10240
    v_smfmac_f32_32x32x32_bf16 v[96:111], v[116:119], v[48:55], v124
    ds_read_b64 v[60:61], v121 offset:11264
    v_exp_f32 v24, v24
    v_exp_f32 v25, v25
    v_exp_f32 v26, v26
    v_exp_f32 v27, v27
    v_mfma_f32_32x32x16_bf16 v[40:55], v[16:19], v[8:11], 0
    s_mov_b64 exec, s[34:35]
    ds_read_b128 v[68:71], v123 offset:7040
    ds_read_b128 v[64:67], v122 offset:8960
    s_mov_b64 exec, -1
    v_exp_f32 v28, v28
    v_exp_f32 v29, v29
    v_exp_f32 v30, v30
    v_exp_f32 v31, v31
    v_mfma_f32_32x32x16_bf16 v[40:55], v[20:23], v[12:15], v[40:55]
    v_exp_f32 v32, v32
    v_exp_f32 v33, v33
    v_exp_f32 v34, v34
    v_exp_f32 v35, v35
    v_smfmac_f32_32x32x32_bf16 v[96:111], v[112:115], v[24:31], v124
    v_exp_f32 v36, v36
    v_exp_f32 v37, v37
    v_exp_f32 v38, v38
    v_exp_f32 v39, v39
    s_waitcnt lgkmcnt(0)
    ds_read_b128 v[16:19], v120 offset:12800
    v_smfmac_f32_32x32x32_bf16 v[96:111], v[68:71], v[32:39], v124
    ds_read_b64 v[20:21], v121 offset:13824
    v_exp_f32 v40, v40
    v_exp_f32 v41, v41
    v_exp_f32 v42, v42
    v_exp_f32 v43, v43
    v_mfma_f32_32x32x16_bf16 v[24:39], v[56:59], v[8:11], 0
    s_mov_b64 exec, s[34:35]
    ds_read_b128 v[116:119], v123 offset:9600
    ds_read_b128 v[112:115], v122 offset:11520
    s_mov_b64 exec, -1
    v_exp_f32 v44, v44
    v_exp_f32 v45, v45
    v_exp_f32 v46, v46
    v_exp_f32 v47, v47
    v_mfma_f32_32x32x16_bf16 v[24:39], v[60:63], v[12:15], v[24:39]
    v_exp_f32 v48, v48
    v_exp_f32 v49, v49
    v_exp_f32 v50, v50
    v_exp_f32 v51, v51
    v_smfmac_f32_32x32x32_bf16 v[96:111], v[64:67], v[40:47], v124
    v_exp_f32 v52, v52
    v_exp_f32 v53, v53
    v_exp_f32 v54, v54
    v_exp_f32 v55, v55
    s_waitcnt lgkmcnt(0)
    ds_read_b128 v[56:59], v120 offset:15360
    v_smfmac_f32_32x32x32_bf16 v[96:111], v[116:119], v[48:55], v124
    ds_read_b64 v[60:61], v121 offset:16384
    v_exp_f32 v24, v24
    v_exp_f32 v25, v25
    v_exp_f32 v26, v26
    v_exp_f32 v27, v27
    v_mfma_f32_32x32x16_bf16 v[40:55], v[16:19], v[8:11], 0
    s_mov_b64 exec, s[34:35]
    ds_read_b128 v[68:71], v123 offset:12160
    ds_read_b128 v[64:67], v122 offset:14080
    s_mov_b64 exec, -1
    v_exp_f32 v28, v28
    v_exp_f32 v29, v29
    v_exp_f32 v30, v30
    v_exp_f32 v31, v31
    v_mfma_f32_32x32x16_bf16 v[40:55], v[20:23], v[12:15], v[40:55]
    v_exp_f32 v32, v32
    v_exp_f32 v33, v33
    v_exp_f32 v34, v34
    v_exp_f32 v35, v35
    v_smfmac_f32_32x32x32_bf16 v[96:111], v[112:115], v[24:31], v124
    v_exp_f32 v36, v36
    v_exp_f32 v37, v37
    v_exp_f32 v38, v38
    v_exp_f32 v39, v39
    s_waitcnt lgkmcnt(0)
    ds_read_b128 v[16:19], v120 offset:17920
    v_smfmac_f32_32x32x32_bf16 v[96:111], v[68:71], v[32:39], v124
    ds_read_b64 v[20:21], v121 offset:18944
    v_exp_f32 v40, v40
    v_exp_f32 v41, v41
    v_exp_f32 v42, v42
    v_exp_f32 v43, v43
    v_mfma_f32_32x32x16_bf16 v[24:39], v[56:59], v[8:11], 0
    s_mov_b64 exec, s[34:35]
    ds_read_b128 v[116:119], v123 offset:14720
    ds_read_b128 v[112:115], v122 offset:16640
    s_mov_b64 exec, -1
    v_exp_f32 v44, v44
    v_exp_f32 v45, v45
    v_exp_f32 v46, v46
    v_exp_f32 v47, v47
    v_mfma_f32_32x32x16_bf16 v[24:39], v[60:63], v[12:15], v[24:39]
    v_exp_f32 v48, v48
    v_exp_f32 v49, v49
    v_exp_f32 v50, v50
    v_exp_f32 v51, v51
    v_smfmac_f32_32x32x32_bf16 v[96:111], v[64:67], v[40:47], v124
    v_exp_f32 v52, v52
    v_exp_f32 v53, v53
    v_exp_f32 v54, v54
    v_exp_f32 v55, v55
    s_cmp_lg_u32 s74, 7
    s_cbranch_scc1 A2_NH
    s_waitcnt vmcnt(0)
    v_cmp_ne_u32 vcc, v3, v73
    v_cmp_eq_u32 s[64:65], 0, v73
    s_or_b64 vcc, vcc, s[64:65]
    s_cbranch_scc0 A2_PF
    s_mov_b32 s60, 16384
PL_10:
    v_mov_b32 v4, 0
    buffer_load_dword v3, v4, s[24:27], 0 offen sc1
    buffer_load_dword v73, v72, s[8:11], 0 offen sc1
    s_waitcnt vmcnt(0)
    v_cmp_eq_u32 vcc, 0, v3
    v_cmp_ne_u32 s[64:65], v3, v73
    s_or_b64 vcc, vcc, s[64:65]
    s_cbranch_scc0 PD_9
    s_sleep 4
    s_sub_u32 s60, s60, 1
    s_cmp_lg_u32 s60, 0
    s_cbranch_scc1 PL_10
PD_9:
A2_PF:
    s_mov_b32 s66, 16384
    v_mov_b32 v4, 0
GL_11:
    s_waitcnt vmcnt(0)
    v_cmp_ne_u32 vcc, 0, v3
    s_nop 0
    s_cbranch_vccnz GK_12
    buffer_load_dword v3, v4, s[24:27], 0 offen sc1
    s_sub_u32 s66, s66, 1
    s_cmp_lg_u32 s66, 0
    s_cbranch_scc1 GL_11
GK_12:
    s_mov_b64 exec, 1
    buffer_store_dword v3, v4, s[8:11], s79 offen sc1
    s_mov_b64 exec, -1
A2_NH:
    s_cmp_eq_u32 s74, 7
    s_cbranch_scc1 A2_NODMA
    s_waitcnt vmcnt(0)
    s_barrier
    s_cmp_ge_u32 s74, 6
    s_cbranch_scc1 A2_LC
    s_setprio 3
    s_add_u32 m0, s73, 0
    s_add_u32 s60, s72, 0
    buffer_load_dwordx4 v2, s[8:11], s60 offen sc1 lds
    s_add_u32 m0, s73, 8192
    s_add_u32 s60, s72, 8192
    buffer_load_dwordx4 v2, s[8:11], s60 offen sc1 lds
    s_cmp_ge_u32 s3, 4
    s_cbranch_scc1 A2_DSc
    s_add_u32 m0, s73, 16384
    s_add_u32 s60, s72, 16384
    buffer_load_dwordx4 v2, s[8:11], s60 offen sc1 lds
A2_DSc:
    s_add_u32 s72, s72, 20480
    s_add_u32 s73, s73, 20480
    s_cmp_ge_u32 s73, 61440
    s_cbranch_scc0 A2_DWc
    s_sub_u32 s73, s73, 61440
A2_DWc:
    s_setprio 1
    s_branch A2_NODMA
A2_LC:
    v_mov_b32 v4, 0
    buffer_load_dword v3, v4, s[24:27], 0 offen sc1
    buffer_load_dword v73, v72, s[8:11], 0 offen sc1
A2_NODMA:
    v_add_u32 v120, s75, v120
    v_add_u32 v121, s75, v121
    s_waitcnt lgkmcnt(0)
    ds_read_b128 v[56:59], v120 offset:0
    v_smfmac_f32_32x32x32_bf16 v[96:111], v[116:119], v[48:55], v124
    ds_read_b64 v[60:61], v121 offset:1024
    v_exp_f32 v24, v24
    v_exp_f32 v25, v25
    v_exp_f32 v26, v26
    v_exp_f32 v27, v27
    v_mfma_f32_32x32x16_bf16 v[40:55], v[16:19], v[8:11], 0
    s_mov_b64 exec, s[34:35]
    ds_read_b128 v[68:71], v123 offset:17280
    ds_read_b128 v[64:67], v122 offset:19200
    s_mov_b64 exec, -1
    v_exp_f32 v28, v28
    v_exp_f32 v29, v29
    v_exp_f32 v30, v30
    v_exp_f32 v31, v31
    v_mfma_f32_32x32x16_bf16 v[40:55], v[20:23], v[12:15], v[40:55]
    v_exp_f32 v32, v32
    v_exp_f32 v33, v33
    v_exp_f32 v34, v34
    v_exp_f32 v35, v35
    v_smfmac_f32_32x32x32_bf16 v[96:111], v[112:115], v[24:31], v124
    v_exp_f32 v36, v36
    v_exp_f32 v37, v37
    v_exp_f32 v38, v38
    v_exp_f32 v39, v39
    v_add_u32 v122, s75, v122
    s_waitcnt lgkmcnt(0)
    ds_read_b128 v[16:19], v120 offset:2560
    v_smfmac_f32_32x32x32_bf16 v[96:111], v[68:71], v[32:39], v124
    ds_read_b64 v[20:21], v121 offset:3584
    v_exp_f32 v40, v40
    v_exp_f32 v41, v41
    v_exp_f32 v42, v42
    v_exp_f32 v43, v43
    v_mfma_f32_32x32x16_bf16 v[24:39], v[56:59], v[8:11], 0
    s_mov_b64 exec, s[34:35]
    ds_read_b128 v[116:119], v123 offset:19840
    ds_read_b128 v[112:115], v122 offset:1280
    s_mov_b64 exec, -1
    v_exp_f32 v44, v44
    v_exp_f32 v45, v45
    v_exp_f32 v46, v46
    v_exp_f32 v47, v47
    v_mfma_f32_32x32x16_bf16 v[24:39], v[60:63], v[12:15], v[24:39]
    v_exp_f32 v48, v48
    v_exp_f32 v49, v49
    v_exp_f32 v50, v50
    v_exp_f32 v51, v51
    v_smfmac_f32_32x32x32_bf16 v[96:111], v[64:67], v[40:47], v124
    v_exp_f32 v52, v52
    v_exp_f32 v53, v53
    v_exp_f32 v54, v54
    v_exp_f32 v55, v55
    v_add_u32 v123, s75, v123
    s_add_u32 s74, s74, 1
    s_cmp_lt_u32 s74, 8
    s_cbranch_scc1 A2_LOOP
    s_setprio 3
    s_waitcnt lgkmcnt(0)
    v_smfmac_f32_32x32x32_bf16 v[96:111], v[116:119], v[48:55], v124
    s_nop 11
    v_rcp_f32 v7, v108
    s_nop 0
    v_mul_f32 v96, v7, v96
    v_mul_f32 v97, v7, v97
    v_mul_f32 v98, v7, v98
    v_mul_f32 v99, v7, v99
    v_mul_f32 v100, v7, v100
    v_mul_f32 v101, v7, v101
    v_mul_f32 v102, v7, v102
    v_mul_f32 v103, v7, v103
    v_mul_f32 v104, v7, v104
    v_mul_f32 v105, v7, v105
    v_mul_f32 v106, v7, v106
    v_mul_f32 v107, v7, v107
    v_cvt_pk_bf16_f32 v24, v96, v97
    v_cvt_pk_bf16_f32 v25, v98, v99
    v_cvt_pk_bf16_f32 v26, v100, v101
    v_cvt_pk_bf16_f32 v27, v102, v103
    v_cvt_pk_bf16_f32 v28, v104, v105
    v_cvt_pk_bf16_f32 v29, v106, v107
    buffer_store_dwordx2 v[24:25], v125, s[8:11], s78 offen sc1
    buffer_store_dwordx2 v[26:27], v126, s[8:11], s78 offen sc1
    s_mov_b32 exec_hi, 0
    buffer_store_dwordx2 v[28:29], v127, s[8:11], s78 offen sc1
    s_mov_b64 exec, -1
    s_endpgm
A2_FB:
    v_mov_b32 v6, 0xff800000
    s_mov_b32 s60, 0x280000
A2_FBL:
    buffer_load_dwordx4 v[16:19], v120, s[8:11], s60 offen sc1
    buffer_load_dwordx2 v[20:21], v121, s[8:11], s60 offen offset:1024 sc1
    s_waitcnt vmcnt(0)
    v_mfma_f32_32x32x16_bf16 v[24:39], v[16:19], v[8:11], 0
    v_mfma_f32_32x32x16_bf16 v[24:39], v[20:23], v[12:15], v[24:39]
    s_nop 15
    v_max3_f32 v6, v6, v24, v25
    v_max3_f32 v6, v6, v26, v27
    v_max3_f32 v6, v6, v28, v29
    v_max3_f32 v6, v6, v30, v31
    v_max3_f32 v6, v6, v32, v33
    v_max3_f32 v6, v6, v34, v35
    v_max3_f32 v6, v6, v36, v37
    v_max3_f32 v6, v6, v38, v39
    s_add_u32 s60, s60, 2560
    s_cmp_lt_u32 s60, 0x2a8000
    s_cbranch_scc1 A2_FBL
    v_mov_b32 v7, v6
    s_nop 1
    v_permlane32_swap_b32 v7, v6
    s_nop 1
    v_max_f32 v6, v6, v7
    s_branch A2_SETM
ROLE_F:
    s_setprio 2
    s_and_b32 s60, s31, 3
    s_lshr_b32 s71, s32, 3
    s_sub_u32 s71, 3, s71
    s_lshl_b32 s71, s71, 2
    s_add_u32 s71, s71, s60
    s_and_b32 s60, s32, 7
    s_and_b32 s70, s31, 4
    s_lshl_b32 s70, s70, 1
    s_add_u32 s70, s70, s60
    s_lshl_b32 s60, s70, 4
    s_add_u32 s60, s60, s3
    s_mul_i32 s74, s60, 10240
    s_lshl_b32 s77, s3, 10
    s_mov_b32 s76, s77
    s_mov_b32 m0, s76
    s_add_u32 s60, s74, 81920
    buffer_load_dwordx4 v8, s[12:15], s74 offen lds
    s_add_u32 m0, s76, 8192
    s_add_u32 s74, s74, 128
    buffer_load_dwordx4 v8, s[12:15], s60 offen lds
    s_xor_b32 s76, s76, 16384
    s_lshr_b32 s60, s3, 2
    s_lshl_b32 s80, s71, 1
    s_add_u32 s80, s80, s60
    s_add_u32 s80, s80, 27
    s_and_b32 s80, s80, 31
    s_lshl_b32 s61, s80, 7
    s_lshl_b32 s62, s80, 8
    s_sub_u32 s62, s62, 6912
    s_cmp_lt_u32 s80, 27
    s_cselect_b32 s79, 1, 0
    s_cselect_b32 s75, s61, s62
    s_mov_b32 s63, 0x500
    s_cmov_b32 s63, 0xd80
    s_cselect_b32 s16, s48, s38
    s_cselect_b32 s17, s49, s39
    s_mov_b32 s18, 0xc8000
    s_cmov_b32 s18, 0x21c000
    s_mov_b32 s19, 0x20000
    s_cselect_b32 s20, s50, s38
    s_cselect_b32 s21, s51, s39
    s_mov_b32 s22, s18
    s_mov_b32 s23, 0x20000
    s_cselect_b32 s64, 32, 128
    s_lshl_b32 s81, s63, 5
    s_and_b32 s60, s3, 3
    s_mul_i32 s60, s60, s63
    s_lshl_b32 s60, s60, 3
    s_add_u32 s75, s75, s60
    v_lshrrev_b32 v6, 5, v1
    v_bfe_u32 v5, v1, 2, 2
    v_lshl_add_u32 v4, v6, 2, v5
    v_mul_lo_u32 v4, v4, s63
    v_bfe_u32 v7, v1, 4, 1
    v_lshl_add_u32 v4, v7, 6, v4
    v_and_b32 v7, 3, v1
    v_lshl_add_u32 v9, v7, 4, v4
    v_xor_b32 v10, s64, v9
    s_add_u32 m0, s77, 32768
    s_nop 0
    buffer_load_dwordx4 v9, s[16:19], s75 offen lds
    s_add_u32 m0, s77, 40960
    s_nop 0
    buffer_load_dwordx4 v10, s[20:23], s75 offen lds
    s_add_u32 s75, s75, s81
    s_add_u32 m0, s77, 49152
    s_nop 0
    buffer_load_dwordx4 v9, s[16:19], s75 offen lds
    s_add_u32 m0, s77, 57344
    s_nop 0
    buffer_load_dwordx4 v10, s[20:23], s75 offen lds
    s_add_u32 s75, s75, s81
    s_mov_b32 m0, s76
    s_add_u32 s60, s74, 81920
    buffer_load_dwordx4 v8, s[12:15], s74 offen lds
    s_add_u32 m0, s76, 8192
    s_add_u32 s74, s74, 128
    buffer_load_dwordx4 v8, s[12:15], s60 offen lds
    s_xor_b32 s76, s76, 16384
    s_add_u32 m0, s77, 65536
    s_nop 0
    buffer_load_dwordx4 v9, s[16:19], s75 offen lds
    s_add_u32 m0, s77, 73728
    s_nop 0
    buffer_load_dwordx4 v10, s[20:23], s75 offen lds
    s_add_u32 s75, s75, s81
    s_and_b32 s72, s3, 1
    s_lshr_b32 s73, s3, 1
    v_bfe_u32 v5, v1, 2, 2
    v_and_b32 v4, 31, v1
    v_bfe_u32 v7, v1, 1, 3
    v_xor_b32 v7, v7, v6
    v_lshlrev_b32 v7, 4, v7
    v_lshl_add_u32 v7, v4, 7, v7
    s_lshl_b32 s60, s72, 13
    v_add_u32 v12, s60, v7
    v_xor_b32 v13, 32, v12
    v_and_b32 v4, 1, v1
    v_lshlrev_b32 v4, 4, v4
    v_bfe_u32 v7, v1, 1, 1
    v_lshl_add_u32 v4, v7, 3, v4
    v_lshl_add_u32 v4, v5, 6, v4
    v_lshl_add_u32 v4, v6, 10, v4
    s_cmp_lg_u32 s79, 0
    s_cselect_b32 s61, 8224, 32
    s_cselect_b32 s62, 32, 8192
    v_bfe_u32 v7, v1, 4, 1
    v_mul_lo_u32 v7, v7, s61
    s_lshr_b32 s60, s3, 2
    s_lshl_b32 s60, s60, 12
    s_and_b32 s63, s73, 1
    s_lshl_b32 s63, s63, 8
    s_add_u32 s60, s60, s63
    s_add_u32 s60, s60, 32768
    v_add3_u32 v14, v4, v7, s60
    v_xor_b32 v15, s62, v14
    v_mov_b32 v56, 0
    v_mov_b32 v57, 0
    v_mov_b32 v58, 0
    v_mov_b32 v59, 0
    v_mov_b32 v60, 0
    v_mov_b32 v61, 0
    v_mov_b32 v62, 0
    v_mov_b32 v63, 0
    v_mov_b32 v64, 0
    v_mov_b32 v65, 0
    v_mov_b32 v66, 0
    v_mov_b32 v67, 0
    v_mov_b32 v68, 0
    v_mov_b32 v69, 0
    v_mov_b32 v70, 0
    v_mov_b32 v71, 0
    v_mov_b32 v72, 0
    v_mov_b32 v73, 0
    v_mov_b32 v74, 0
    v_mov_b32 v75, 0
    v_mov_b32 v76, 0
    v_mov_b32 v77, 0
    v_mov_b32 v78, 0
    v_mov_b32 v79, 0
    v_mov_b32 v80, 0
    v_mov_b32 v81, 0
    v_mov_b32 v82, 0
    v_mov_b32 v83, 0
    v_mov_b32 v84, 0
    v_mov_b32 v85, 0
    v_mov_b32 v86, 0
    v_mov_b32 v87, 0
    v_mov_b32 v88, 0
    v_mov_b32 v89, 0
    v_mov_b32 v90, 0
    v_mov_b32 v91, 0
    v_mov_b32 v92, 0
    v_mov_b32 v93, 0
    v_mov_b32 v94, 0
    v_mov_b32 v95, 0
    v_mov_b32 v96, 0
    v_mov_b32 v97, 0
    v_mov_b32 v98, 0
    v_mov_b32 v99, 0
    v_mov_b32 v100, 0
    v_mov_b32 v101, 0
    v_mov_b32 v102, 0
    v_mov_b32 v103, 0
    v_mov_b32 v104, 0
    v_mov_b32 v105, 0
    v_mov_b32 v106, 0
    v_mov_b32 v107, 0
    v_mov_b32 v108, 0
    v_mov_b32 v109, 0
    v_mov_b32 v110, 0
    v_mov_b32 v111, 0
    v_mov_b32 v112, 0
    v_mov_b32 v113, 0
    v_mov_b32 v114, 0
    v_mov_b32 v115, 0
    v_mov_b32 v116, 0
    v_mov_b32 v117, 0
    v_mov_b32 v118, 0
    v_mov_b32 v119, 0
    s_lshl_b32 s82, s70, 1
    s_add_u32 s82, s82, s72
    s_and_b32 s64, s73, 1
    s_lshl_b32 s62, s80, 1
    s_add_u32 s83, s62, s64
    s_lshl_b32 s61, s82, 9
    s_add_u32 s60, s61, 0x2a9000
    v_and_b32 v4, 31, v1
    v_lshl_add_u32 v122, v4, 3, s60
    s_add_u32 s61, s61, 0x2b000c
    s_lshl_b32 s65, s83, 7
    s_lshl_b32 s63, s80, 9
    s_lshl_b32 s64, s64, 7
    s_add_u32 s63, s63, s64
    s_add_u32 s63, s63, 512
    s_cmp_lg_u32 s79, 0
    s_cselect_b32 s62, s80, s62
    s_cselect_b32 s65, s65, s63
    s_cselect_b32 s84, 64, 256
    s_cselect_b32 s66, 7168, 64
    s_mov_b32 s63, 0x80
    s_cmov_b32 s63, 0xd80
    s_add_u32 s65, s65, 0x2c8000
    s_lshl_b32 s62, s62, 7
    s_add_u32 s62, s62, 0x5be000
    v_and_b32 v5, 1, v1
    v_lshlrev_b32 v4, 7, v5
    v_add_u32 v120, s61, v4
    v_mul_lo_u32 v5, v5, s63
    s_mov_b32 exec_lo, 0
    v_add_u32 v120, s62, v5
    s_mov_b64 exec, -1
    v_bfe_u32 v4, v1, 4, 1
    v_mul_lo_u32 v4, v4, s66
    v_and_b32 v5, 3, v1
    v_lshl_add_u32 v4, v5, 2, v4
    v_bfe_u32 v5, v1, 2, 1
    v_lshl_add_u32 v4, v5, 5, v4
    v_bfe_u32 v5, v1, 3, 1
    v_lshl_add_u32 v4, v5, 4, v4
    v_add_u32 v121, s65, v4
    s_mov_b32 s85, 0
    s_mov_b32 s78, 0
    s_waitcnt vmcnt(6)
    s_barrier
    ds_read_b128 v[24:27], v12
    ds_read_b64_tr_b16 v[32:33], v14 offset:0
    ds_read_b64_tr_b16 v[34:35], v14 offset:512
    ds_read_b64_tr_b16 v[36:37], v15 offset:0
    ds_read_b64_tr_b16 v[38:39], v15 offset:512
    ds_read_b128 v[28:31], v12 offset:4096
F1_LOOP:
    s_cmp_lg_u32 s78, 18
    s_cbranch_scc1 F1_P2
    v_cmp_ne_u32 vcc, v3, v22
    v_cmp_eq_u32 s[64:65], 0, v22
    s_or_b64 vcc, vcc, s[64:65]
    s_cbranch_scc1 F1_P2
    s_mov_b32 s85, 1
    buffer_load_dwordx2 v[16:17], v122, s[8:11], 0 offen sc1
    buffer_load_dwordx2 v[18:19], v122, s[8:11], 0 offen offset:256 sc1
    buffer_load_dword v20, v121, s[8:11], 0 offen sc1
    buffer_load_dword v21, v121, s[8:11], s84 offen sc1
F1_P2:
    s_waitcnt lgkmcnt(0)
    v_mfma_f32_32x32x16_bf16 v[56:71], v[32:35], v[24:27], v[56:71]
    ds_read_b128 v[40:43], v13
    ds_read_b64_tr_b16 v[48:49], v14 offset:2048
    ds_read_b64_tr_b16 v[50:51], v14 offset:2560
    ds_read_b64_tr_b16 v[52:53], v15 offset:2048
    ds_read_b64_tr_b16 v[54:55], v15 offset:2560
    ds_read_b128 v[44:47], v13 offset:4096
    v_mfma_f32_32x32x16_bf16 v[72:87], v[36:39], v[24:27], v[72:87]
    v_xor_b32 v12, 0x40, v12
    v_xor_b32 v13, 0x40, v13
    v_mfma_f32_32x32x16_bf16 v[88:103], v[32:35], v[28:31], v[88:103]
    s_cmp_ge_u32 s78, 17
    s_cbranch_scc1 F1_T0
    s_waitcnt vmcnt(4) lgkmcnt(0)
    v_mfma_f32_32x32x16_bf16 v[104:119], v[36:39], v[28:31], v[104:119]
    s_barrier
    v_mfma_f32_32x32x16_bf16 v[56:71], v[48:51], v[40:43], v[56:71]
    ds_read_b128 v[24:27], v12
    ds_read_b64_tr_b16 v[32:33], v14 offset:16384
    ds_read_b64_tr_b16 v[34:35], v14 offset:16896
    ds_read_b64_tr_b16 v[36:37], v15 offset:16384
    ds_read_b64_tr_b16 v[38:39], v15 offset:16896
    ds_read_b128 v[28:31], v12 offset:4096
    v_mfma_f32_32x32x16_bf16 v[72:87], v[52:55], v[40:43], v[72:87]
    s_add_u32 m0, s77, 32768
    s_nop 0
    buffer_load_dwordx4 v9, s[16:19], s75 offen lds
    s_add_u32 m0, s77, 40960
    s_nop 0
    buffer_load_dwordx4 v10, s[20:23], s75 offen lds
    s_add_u32 s75, s75, s81
    v_mfma_f32_32x32x16_bf16 v[88:103], v[48:51], v[44:47], v[88:103]
    v_mfma_f32_32x32x16_bf16 v[104:119], v[52:55], v[44:47], v[104:119]
    s_branch F1_N0
F1_T0:
    s_waitcnt lgkmcnt(0)
    v_mfma_f32_32x32x16_bf16 v[104:119], v[36:39], v[28:31], v[104:119]
    s_barrier
    v_mfma_f32_32x32x16_bf16 v[56:71], v[48:51], v[40:43], v[56:71]
    ds_read_b128 v[24:27], v12
    ds_read_b64_tr_b16 v[32:33], v14 offset:16384
    ds_read_b64_tr_b16 v[34:35], v14 offset:16896
    ds_read_b64_tr_b16 v[36:37], v15 offset:16384
    ds_read_b64_tr_b16 v[38:39], v15 offset:16896
    ds_read_b128 v[28:31], v12 offset:4096
    v_mfma_f32_32x32x16_bf16 v[72:87], v[52:55], v[40:43], v[72:87]
    v_mfma_f32_32x32x16_bf16 v[88:103], v[48:51], v[44:47], v[88:103]
    v_mfma_f32_32x32x16_bf16 v[104:119], v[52:55], v[44:47], v[104:119]
F1_N0:
    s_add_u32 s78, s78, 1
    s_waitcnt lgkmcnt(0)
    v_mfma_f32_32x32x16_bf16 v[56:71], v[32:35], v[24:27], v[56:71]
    ds_read_b128 v[40:43], v13
    ds_read_b64_tr_b16 v[48:49], v14 offset:18432
    ds_read_b64_tr_b16 v[50:51], v14 offset:18944
    ds_read_b64_tr_b16 v[52:53], v15 offset:18432
    ds_read_b64_tr_b16 v[54:55], v15 offset:18944
    ds_read_b128 v[44:47], v13 offset:4096
    v_mfma_f32_32x32x16_bf16 v[72:87], v[36:39], v[24:27], v[72:87]
    v_xor_b32 v12, 0x4040, v12
    v_xor_b32 v13, 0x4040, v13
    v_mfma_f32_32x32x16_bf16 v[88:103], v[32:35], v[28:31], v[88:103]
    s_cmp_eq_u32 s78, 19
    s_cbranch_scc1 F1_LAST
    s_waitcnt vmcnt(2) lgkmcnt(0)
    v_mfma_f32_32x32x16_bf16 v[104:119], v[36:39], v[28:31], v[104:119]
    s_barrier
    v_mfma_f32_32x32x16_bf16 v[56:71], v[48:51], v[40:43], v[56:71]
    ds_read_b128 v[24:27], v12
    ds_read_b64_tr_b16 v[32:33], v14 offset:32768
    ds_read_b64_tr_b16 v[34:35], v14 offset:33280
    ds_read_b64_tr_b16 v[36:37], v15 offset:32768
    ds_read_b64_tr_b16 v[38:39], v15 offset:33280
    ds_read_b128 v[28:31], v12 offset:4096
    v_mfma_f32_32x32x16_bf16 v[72:87], v[52:55], v[40:43], v[72:87]
    s_add_u32 m0, s77, 49152
    s_nop 0
    buffer_load_dwordx4 v9, s[16:19], s75 offen lds
    s_add_u32 m0, s77, 57344
    s_nop 0
    buffer_load_dwordx4 v10, s[20:23], s75 offen lds
    s_add_u32 s75, s75, s81
    v_mfma_f32_32x32x16_bf16 v[88:103], v[48:51], v[44:47], v[88:103]
    s_mov_b32 m0, s76
    s_add_u32 s60, s74, 81920
    buffer_load_dwordx4 v8, s[12:15], s74 offen lds
    s_add_u32 m0, s76, 8192
    s_add_u32 s74, s74, 128
    buffer_load_dwordx4 v8, s[12:15], s60 offen lds
    s_xor_b32 s76, s76, 16384
    v_mfma_f32_32x32x16_bf16 v[104:119], v[52:55], v[44:47], v[104:119]
    s_add_u32 s78, s78, 1
    s_waitcnt lgkmcnt(0)
    v_mfma_f32_32x32x16_bf16 v[56:71], v[32:35], v[24:27], v[56:71]
    ds_read_b128 v[40:43], v13
    ds_read_b64_tr_b16 v[48:49], v14 offset:34816
    ds_read_b64_tr_b16 v[50:51], v14 offset:35328
    ds_read_b64_tr_b16 v[52:53], v15 offset:34816
    ds_read_b64_tr_b16 v[54:55], v15 offset:35328
    ds_read_b128 v[44:47], v13 offset:4096
    v_mfma_f32_32x32x16_bf16 v[72:87], v[36:39], v[24:27], v[72:87]
    v_xor_b32 v12, 0x40, v12
    v_xor_b32 v13, 0x40, v13
    v_mfma_f32_32x32x16_bf16 v[88:103], v[32:35], v[28:31], v[88:103]
    s_waitcnt vmcnt(4) lgkmcnt(0)
    v_mfma_f32_32x32x16_bf16 v[104:119], v[36:39], v[28:31], v[104:119]
    s_barrier
    v_mfma_f32_32x32x16_bf16 v[56:71], v[48:51], v[40:43], v[56:71]
    ds_read_b128 v[24:27], v12
    ds_read_b64_tr_b16 v[32:33], v14 offset:0
    ds_read_b64_tr_b16 v[34:35], v14 offset:512
    ds_read_b64_tr_b16 v[36:37], v15 offset:0
    ds_read_b64_tr_b16 v[38:39], v15 offset:512
    ds_read_b128 v[28:31], v12 offset:4096
    v_mfma_f32_32x32x16_bf16 v[72:87], v[52:55], v[40:43], v[72:87]
    s_add_u32 m0, s77, 65536
    s_nop 0
    buffer_load_dwordx4 v9, s[16:19], s75 offen lds
    s_add_u32 m0, s77, 73728
    s_nop 0
    buffer_load_dwordx4 v10, s[20:23], s75 offen lds
    s_add_u32 s75, s75, s81
    v_mfma_f32_32x32x16_bf16 v[88:103], v[48:51], v[44:47], v[88:103]
    v_mfma_f32_32x32x16_bf16 v[104:119], v[52:55], v[44:47], v[104:119]
    s_add_u32 s78, s78, 1
    s_waitcnt lgkmcnt(0)
    v_mfma_f32_32x32x16_bf16 v[56:71], v[32:35], v[24:27], v[56:71]
    ds_read_b128 v[40:43], v13
    ds_read_b64_tr_b16 v[48:49], v14 offset:2048
    ds_read_b64_tr_b16 v[50:51], v14 offset:2560
    ds_read_b64_tr_b16 v[52:53], v15 offset:2048
    ds_read_b64_tr_b16 v[54:55], v15 offset:2560
    ds_read_b128 v[44:47], v13 offset:4096
    v_mfma_f32_32x32x16_bf16 v[72:87], v[36:39], v[24:27], v[72:87]
    v_xor_b32 v12, 0x4040, v12
    v_xor_b32 v13, 0x4040, v13
    v_mfma_f32_32x32x16_bf16 v[88:103], v[32:35], v[28:31], v[88:103]
    s_waitcnt vmcnt(2) lgkmcnt(0)
    v_mfma_f32_32x32x16_bf16 v[104:119], v[36:39], v[28:31], v[104:119]
    s_barrier
    v_mfma_f32_32x32x16_bf16 v[56:71], v[48:51], v[40:43], v[56:71]
    ds_read_b128 v[24:27], v12
    ds_read_b64_tr_b16 v[32:33], v14 offset:16384
    ds_read_b64_tr_b16 v[34:35], v14 offset:16896
    ds_read_b64_tr_b16 v[36:37], v15 offset:16384
    ds_read_b64_tr_b16 v[38:39], v15 offset:16896
    ds_read_b128 v[28:31], v12 offset:4096
    v_mfma_f32_32x32x16_bf16 v[72:87], v[52:55], v[40:43], v[72:87]
    s_add_u32 m0, s77, 32768
    s_nop 0
    buffer_load_dwordx4 v9, s[16:19], s75 offen lds
    s_add_u32 m0, s77, 40960
    s_nop 0
    buffer_load_dwordx4 v10, s[20:23], s75 offen lds
    s_add_u32 s75, s75, s81
    v_mfma_f32_32x32x16_bf16 v[88:103], v[48:51], v[44:47], v[88:103]
    s_mov_b32 m0, s76
    s_add_u32 s60, s74, 81920
    buffer_load_dwordx4 v8, s[12:15], s74 offen lds
    s_add_u32 m0, s76, 8192
    s_add_u32 s74, s74, 128
    buffer_load_dwordx4 v8, s[12:15], s60 offen lds
    s_xor_b32 s76, s76, 16384
    v_mfma_f32_32x32x16_bf16 v[104:119], v[52:55], v[44:47], v[104:119]
    s_add_u32 s78, s78, 1
    s_cmp_lg_u32 s78, 16
    s_cbranch_scc1 F1_P1
    v_mov_b32 v7, 0
    buffer_load_dword v3, v7, s[24:27], 0 offen sc1
    buffer_load_dword v22, v120, s[8:11], 0 offen sc1
F1_P1:
    s_waitcnt lgkmcnt(0)
    v_mfma_f32_32x32x16_bf16 v[56:71], v[32:35], v[24:27], v[56:71]
    ds_read_b128 v[40:43], v13
    ds_read_b64_tr_b16 v[48:49], v14 offset:18432
    ds_read_b64_tr_b16 v[50:51], v14 offset:18944
    ds_read_b64_tr_b16 v[52:53], v15 offset:18432
    ds_read_b64_tr_b16 v[54:55], v15 offset:18944
    ds_read_b128 v[44:47], v13 offset:4096
    v_mfma_f32_32x32x16_bf16 v[72:87], v[36:39], v[24:27], v[72:87]
    v_xor_b32 v12, 0x40, v12
    v_xor_b32 v13, 0x40, v13
    v_mfma_f32_32x32x16_bf16 v[88:103], v[32:35], v[28:31], v[88:103]
    s_waitcnt vmcnt(4) lgkmcnt(0)
    v_mfma_f32_32x32x16_bf16 v[104:119], v[36:39], v[28:31], v[104:119]
    s_barrier
    v_mfma_f32_32x32x16_bf16 v[56:71], v[48:51], v[40:43], v[56:71]
    ds_read_b128 v[24:27], v12
    ds_read_b64_tr_b16 v[32:33], v14 offset:32768
    ds_read_b64_tr_b16 v[34:35], v14 offset:33280
    ds_read_b64_tr_b16 v[36:37], v15 offset:32768
    ds_read_b64_tr_b16 v[38:39], v15 offset:33280
    ds_read_b128 v[28:31], v12 offset:4096
    v_mfma_f32_32x32x16_bf16 v[72:87], v[52:55], v[40:43], v[72:87]
    s_add_u32 m0, s77, 49152
    s_nop 0
    buffer_load_dwordx4 v9, s[16:19], s75 offen lds
    s_add_u32 m0, s77, 57344
    s_nop 0
    buffer_load_dwordx4 v10, s[20:23], s75 offen lds
    s_add_u32 s75, s75, s81
    v_mfma_f32_32x32x16_bf16 v[88:103], v[48:51], v[44:47], v[88:103]
    v_mfma_f32_32x32x16_bf16 v[104:119], v[52:55], v[44:47], v[104:119]
    s_add_u32 s78, s78, 1
    s_waitcnt lgkmcnt(0)
    v_mfma_f32_32x32x16_bf16 v[56:71], v[32:35], v[24:27], v[56:71]
    ds_read_b128 v[40:43], v13
    ds_read_b64_tr_b16 v[48:49], v14 offset:34816
    ds_read_b64_tr_b16 v[50:51], v14 offset:35328
    ds_read_b64_tr_b16 v[52:53], v15 offset:34816
    ds_read_b64_tr_b16 v[54:55], v15 offset:35328
    ds_read_b128 v[44:47], v13 offset:4096
    v_mfma_f32_32x32x16_bf16 v[72:87], v[36:39], v[24:27], v[72:87]
    v_xor_b32 v12, 0x4040, v12
    v_xor_b32 v13, 0x4040, v13
    v_mfma_f32_32x32x16_bf16 v[88:103], v[32:35], v[28:31], v[88:103]
    s_cmp_ge_u32 s78, 17
    s_cbranch_scc1 F1_T5
    s_waitcnt vmcnt(2) lgkmcnt(0)
    v_mfma_f32_32x32x16_bf16 v[104:119], v[36:39], v[28:31], v[104:119]
    s_barrier
    v_mfma_f32_32x32x16_bf16 v[56:71], v[48:51], v[40:43], v[56:71]
    ds_read_b128 v[24:27], v12
    ds_read_b64_tr_b16 v[32:33], v14 offset:0
    ds_read_b64_tr_b16 v[34:35], v14 offset:512
    ds_read_b64_tr_b16 v[36:37], v15 offset:0
    ds_read_b64_tr_b16 v[38:39], v15 offset:512
    ds_read_b128 v[28:31], v12 offset:4096
    v_mfma_f32_32x32x16_bf16 v[72:87], v[52:55], v[40:43], v[72:87]
    s_add_u32 m0, s77, 65536
    s_nop 0
    buffer_load_dwordx4 v9, s[16:19], s75 offen lds
    s_add_u32 m0, s77, 73728
    s_nop 0
    buffer_load_dwordx4 v10, s[20:23], s75 offen lds
    s_add_u32 s75, s75, s81
    v_mfma_f32_32x32x16_bf16 v[88:103], v[48:51], v[44:47], v[88:103]
    s_mov_b32 m0, s76
    s_add_u32 s60, s74, 81920
    buffer_load_dwordx4 v8, s[12:15], s74 offen lds
    s_add_u32 m0, s76, 8192
    s_add_u32 s74, s74, 128
    buffer_load_dwordx4 v8, s[12:15], s60 offen lds
    s_xor_b32 s76, s76, 16384
    v_mfma_f32_32x32x16_bf16 v[104:119], v[52:55], v[44:47], v[104:119]
    s_branch F1_N5
F1_T5:
    s_waitcnt vmcnt(0) lgkmcnt(0)
    v_mfma_f32_32x32x16_bf16 v[104:119], v[36:39], v[28:31], v[104:119]
    s_barrier
    v_mfma_f32_32x32x16_bf16 v[56:71], v[48:51], v[40:43], v[56:71]
    ds_read_b128 v[24:27], v12
    ds_read_b64_tr_b16 v[32:33], v14 offset:0
    ds_read_b64_tr_b16 v[34:35], v14 offset:512
    ds_read_b64_tr_b16 v[36:37], v15 offset:0
    ds_read_b64_tr_b16 v[38:39], v15 offset:512
    ds_read_b128 v[28:31], v12 offset:4096
    v_mfma_f32_32x32x16_bf16 v[72:87], v[52:55], v[40:43], v[72:87]
    v_mfma_f32_32x32x16_bf16 v[88:103], v[48:51], v[44:47], v[88:103]
    v_mfma_f32_32x32x16_bf16 v[104:119], v[52:55], v[44:47], v[104:119]
F1_N5:
    s_add_u32 s78, s78, 1
    s_branch F1_LOOP
F1_LAST:
    v_mfma_f32_32x32x16_bf16 v[104:119], v[36:39], v[28:31], v[104:119]
    s_waitcnt lgkmcnt(0)
    s_barrier
    v_mfma_f32_32x32x16_bf16 v[56:71], v[48:51], v[40:43], v[56:71]
    v_mfma_f32_32x32x16_bf16 v[72:87], v[52:55], v[40:43], v[72:87]
    v_mfma_f32_32x32x16_bf16 v[88:103], v[48:51], v[44:47], v[88:103]
    v_mfma_f32_32x32x16_bf16 v[104:119], v[52:55], v[44:47], v[104:119]
    s_setprio 2
    s_cmp_lg_u32 s85, 0
    s_cbranch_scc1 F1_P3
    s_mov_b32 s60, 16384
PL_14:
    v_mov_b32 v7, 0
    buffer_load_dword v3, v7, s[24:27], 0 offen sc1
    buffer_load_dword v22, v120, s[8:11], 0 offen sc1
    s_waitcnt vmcnt(0)
    v_cmp_eq_u32 vcc, 0, v3
    v_cmp_ne_u32 s[64:65], v3, v22
    s_or_b64 vcc, vcc, s[64:65]
    s_cbranch_scc0 PD_13
    s_sleep 2
    s_sub_u32 s60, s60, 1
    s_cmp_lg_u32 s60, 0
    s_cbranch_scc1 PL_14
PD_13:
    buffer_load_dwordx2 v[16:17], v122, s[8:11], 0 offen sc1
    buffer_load_dwordx2 v[18:19], v122, s[8:11], 0 offen offset:256 sc1
    buffer_load_dword v20, v121, s[8:11], 0 offen sc1
    buffer_load_dword v21, v121, s[8:11], s84 offen sc1
F1_P3:
    s_waitcnt vmcnt(0)
    v_and_b32 v4, 0xffff0000, v20
    v_sub_f32 v5, v20, v4
    v_lshrrev_b32 v25, 16, v4
    v_and_b32 v5, 0xffff0000, v5
    v_or_b32 v24, v25, v5
    v_and_b32 v4, 0xffff0000, v16
    v_sub_f32 v5, v16, v4
    v_lshrrev_b32 v33, 16, v5
    v_lshrrev_b32 v5, 16, v4
    v_or_b32 v32, v4, v5
    v_mov_b32 v26, 0
    v_mov_b32 v34, 0
    v_mov_b32 v27, 0
    v_mov_b32 v35, 0
    v_and_b32 v4, 0xffff0000, v21
    v_sub_f32 v5, v21, v4
    v_lshrrev_b32 v29, 16, v4
    v_and_b32 v5, 0xffff0000, v5
    v_or_b32 v28, v29, v5
    v_and_b32 v4, 0xffff0000, v18
    v_sub_f32 v5, v18, v4
    v_lshrrev_b32 v37, 16, v5
    v_lshrrev_b32 v5, 16, v4
    v_or_b32 v36, v4, v5
    v_mov_b32 v30, 0
    v_mov_b32 v38, 0
    v_mov_b32 v31, 0
    v_mov_b32 v39, 0
    s_mov_b32 exec_lo, 0
    v_mov_b32 v24, 0
    v_mov_b32 v25, 0
    v_mov_b32 v28, 0
    v_mov_b32 v29, 0
    s_mov_b64 exec, -1
    v_lshrrev_b32 v6, 5, v1
    v_and_b32 v4, 15, v1
    v_mfma_f32_32x32x16_bf16 v[56:71], v[24:27], v[32:35], v[56:71]
    v_mfma_f32_32x32x16_bf16 v[72:87], v[28:31], v[32:35], v[72:87]
    v_mfma_f32_32x32x16_bf16 v[88:103], v[24:27], v[36:39], v[88:103]
    v_mfma_f32_32x32x16_bf16 v[104:119], v[28:31], v[36:39], v[104:119]
    v_lshlrev_b32 v4, 4, v4
    v_lshl_add_u32 v4, v6, 8, v4
    v_bfe_u32 v5, v1, 4, 1
    v_lshl_add_u32 v4, v5, 10, v4
    s_mul_i32 s60, s82, 74
    s_add_u32 s60, s60, s83
    s_lshl_b32 s60, s60, 12
    s_add_u32 s60, s60, 0x600000
    s_nop 3
    s_cmp_lg_u32 s79, 0
    s_cbranch_scc1 F1_GU
    s_setprio 3
    s_mul_i32 s60, s82, 81920
    s_sub_u32 s61, s80, 27
    s_lshl_b32 s61, s61, 13
    s_add_u32 s60, s60, s61
    s_and_b32 s64, s73, 1
    s_lshl_b32 s64, s64, 11
    s_add_u32 s60, s60, s64
    v_mul_f32 v5, 0x3ea52b5c, v17
    v_mul_f32 v56, v5, v56
    v_mul_f32 v57, v5, v57
    v_mul_f32 v58, v5, v58
    v_mul_f32 v59, v5, v59
    v_mul_f32 v60, v5, v60
    v_mul_f32 v61, v5, v61
    v_mul_f32 v62, v5, v62
    v_mul_f32 v63, v5, v63
    v_mul_f32 v64, v5, v64
    v_mul_f32 v65, v5, v65
    v_mul_f32 v66, v5, v66
    v_mul_f32 v67, v5, v67
    v_mul_f32 v68, v5, v68
    v_mul_f32 v69, v5, v69
    v_mul_f32 v70, v5, v70
    v_mul_f32 v71, v5, v71
    v_cvt_pk_bf16_f32 v24, v56, v57
    v_cvt_pk_bf16_f32 v25, v58, v59
    v_cvt_pk_bf16_f32 v26, v60, v61
    v_cvt_pk_bf16_f32 v27, v62, v63
    v_cvt_pk_bf16_f32 v28, v64, v65
    v_cvt_pk_bf16_f32 v29, v66, v67
    v_cvt_pk_bf16_f32 v30, v68, v69
    v_cvt_pk_bf16_f32 v31, v70, v71
    s_add_u32 s61, s60, 0
    buffer_store_dwordx4 v[24:27], v2, s[8:11], s61 offen sc1
    buffer_store_dwordx4 v[28:31], v2, s[8:11], s61 offen offset:1024 sc1
    v_mul_f32 v72, v5, v72
    v_mul_f32 v73, v5, v73
    v_mul_f32 v74, v5, v74
    v_mul_f32 v75, v5, v75
    v_mul_f32 v76, v5, v76
    v_mul_f32 v77, v5, v77
    v_mul_f32 v78, v5, v78
    v_mul_f32 v79, v5, v79
    v_mul_f32 v80, v5, v80
    v_mul_f32 v81, v5, v81
    v_mul_f32 v82, v5, v82
    v_mul_f32 v83, v5, v83
    v_mul_f32 v84, v5, v84
    v_mul_f32 v85, v5, v85
    v_mul_f32 v86, v5, v86
    v_mul_f32 v87, v5, v87
    v_cvt_pk_bf16_f32 v32, v72, v73
    v_cvt_pk_bf16_f32 v33, v74, v75
    v_cvt_pk_bf16_f32 v34, v76, v77
    v_cvt_pk_bf16_f32 v35, v78, v79
    v_cvt_pk_bf16_f32 v36, v80, v81
    v_cvt_pk_bf16_f32 v37, v82, v83
    v_cvt_pk_bf16_f32 v38, v84, v85
    v_cvt_pk_bf16_f32 v39, v86, v87
    s_add_u32 s61, s60, 4096
    buffer_store_dwordx4 v[32:35], v2, s[8:11], s61 offen sc1
    buffer_store_dwordx4 v[36:39], v2, s[8:11], s61 offen offset:1024 sc1
    v_mul_f32 v5, 0x3ea52b5c, v19
    v_mul_f32 v88, v5, v88
    v_mul_f32 v89, v5, v89
    v_mul_f32 v90, v5, v90
    v_mul_f32 v91, v5, v91
    v_mul_f32 v92, v5, v92
    v_mul_f32 v93, v5, v93
    v_mul_f32 v94, v5, v94
    v_mul_f32 v95, v5, v95
    v_mul_f32 v96, v5, v96
    v_mul_f32 v97, v5, v97
    v_mul_f32 v98, v5, v98
    v_mul_f32 v99, v5, v99
    v_mul_f32 v100, v5, v100
    v_mul_f32 v101, v5, v101
    v_mul_f32 v102, v5, v102
    v_mul_f32 v103, v5, v103
    v_cvt_pk_bf16_f32 v40, v88, v89
    v_cvt_pk_bf16_f32 v41, v90, v91
    v_cvt_pk_bf16_f32 v42, v92, v93
    v_cvt_pk_bf16_f32 v43, v94, v95
    v_cvt_pk_bf16_f32 v44, v96, v97
    v_cvt_pk_bf16_f32 v45, v98, v99
    v_cvt_pk_bf16_f32 v46, v100, v101
    v_cvt_pk_bf16_f32 v47, v102, v103
    s_add_u32 s61, s60, 40960
    buffer_store_dwordx4 v[40:43], v2, s[8:11], s61 offen sc1
    buffer_store_dwordx4 v[44:47], v2, s[8:11], s61 offen offset:1024 sc1
    v_mul_f32 v104, v5, v104
    v_mul_f32 v105, v5, v105
    v_mul_f32 v106, v5, v106
    v_mul_f32 v107, v5, v107
    v_mul_f32 v108, v5, v108
    v_mul_f32 v109, v5, v109
    v_mul_f32 v110, v5, v110
    v_mul_f32 v111, v5, v111
    v_mul_f32 v112, v5, v112
    v_mul_f32 v113, v5, v113
    v_mul_f32 v114, v5, v114
    v_mul_f32 v115, v5, v115
    v_mul_f32 v116, v5, v116
    v_mul_f32 v117, v5, v117
    v_mul_f32 v118, v5, v118
    v_mul_f32 v119, v5, v119
    v_cvt_pk_bf16_f32 v48, v104, v105
    v_cvt_pk_bf16_f32 v49, v106, v107
    v_cvt_pk_bf16_f32 v50, v108, v109
    v_cvt_pk_bf16_f32 v51, v110, v111
    v_cvt_pk_bf16_f32 v52, v112, v113
    v_cvt_pk_bf16_f32 v53, v114, v115
    v_cvt_pk_bf16_f32 v54, v116, v117
    v_cvt_pk_bf16_f32 v55, v118, v119
    s_add_u32 s61, s60, 45056
    buffer_store_dwordx4 v[48:51], v2, s[8:11], s61 offen sc1
    buffer_store_dwordx4 v[52:55], v2, s[8:11], s61 offen offset:1024 sc1
    s_branch F1_PUB
F1_GU:
    v_mul_f32 v5, 0xbfb8aa3b, v17
    v_mul_f32 v40, v5, v56
    v_mul_f32 v41, v5, v57
    v_mul_f32 v42, v5, v58
    v_mul_f32 v43, v5, v59
    v_mul_f32 v44, v5, v60
    v_mul_f32 v45, v5, v61
    v_mul_f32 v46, v5, v62
    v_mul_f32 v47, v5, v63
    v_exp_f32 v40, v40
    v_exp_f32 v41, v41
    v_exp_f32 v42, v42
    v_exp_f32 v43, v43
    v_exp_f32 v44, v44
    v_exp_f32 v45, v45
    v_exp_f32 v46, v46
    v_exp_f32 v47, v47
    v_mul_f32 v56, v56, v64
    v_mul_f32 v57, v57, v65
    v_mul_f32 v58, v58, v66
    v_mul_f32 v59, v59, v67
    v_mul_f32 v60, v60, v68
    v_mul_f32 v61, v61, v69
    v_mul_f32 v62, v62, v70
    v_mul_f32 v63, v63, v71
    v_add_f32 v40, 1.0, v40
    v_add_f32 v41, 1.0, v41
    v_add_f32 v42, 1.0, v42
    v_add_f32 v43, 1.0, v43
    v_add_f32 v44, 1.0, v44
    v_add_f32 v45, 1.0, v45
    v_add_f32 v46, 1.0, v46
    v_add_f32 v47, 1.0, v47
    v_rcp_f32 v40, v40
    v_rcp_f32 v41, v41
    v_rcp_f32 v42, v42
    v_rcp_f32 v43, v43
    v_rcp_f32 v44, v44
    v_rcp_f32 v45, v45
    v_rcp_f32 v46, v46
    v_rcp_f32 v47, v47
    s_nop 0
    v_mul_f32 v56, v40, v56
    v_mul_f32 v57, v41, v57
    v_mul_f32 v58, v42, v58
    v_mul_f32 v59, v43, v59
    v_mul_f32 v60, v44, v60
    v_mul_f32 v61, v45, v61
    v_mul_f32 v62, v46, v62
    v_mul_f32 v63, v47, v63
    v_cvt_pk_bf16_f32 v24, v56, v57
    v_cvt_pk_bf16_f32 v25, v58, v59
    v_cvt_pk_bf16_f32 v26, v60, v61
    v_cvt_pk_bf16_f32 v27, v62, v63
    v_mul_f32 v40, v5, v72
    v_mul_f32 v41, v5, v73
    v_mul_f32 v42, v5, v74
    v_mul_f32 v43, v5, v75
    v_mul_f32 v44, v5, v76
    v_mul_f32 v45, v5, v77
    v_mul_f32 v46, v5, v78
    v_mul_f32 v47, v5, v79
    v_exp_f32 v40, v40
    v_exp_f32 v41, v41
    v_exp_f32 v42, v42
    v_exp_f32 v43, v43
    v_exp_f32 v44, v44
    v_exp_f32 v45, v45
    v_exp_f32 v46, v46
    v_exp_f32 v47, v47
    v_mul_f32 v72, v72, v80
    v_mul_f32 v73, v73, v81
    v_mul_f32 v74, v74, v82
    v_mul_f32 v75, v75, v83
    v_mul_f32 v76, v76, v84
    v_mul_f32 v77, v77, v85
    v_mul_f32 v78, v78, v86
    v_mul_f32 v79, v79, v87
    v_add_f32 v40, 1.0, v40
    v_add_f32 v41, 1.0, v41
    v_add_f32 v42, 1.0, v42
    v_add_f32 v43, 1.0, v43
    v_add_f32 v44, 1.0, v44
    v_add_f32 v45, 1.0, v45
    v_add_f32 v46, 1.0, v46
    v_add_f32 v47, 1.0, v47
    v_rcp_f32 v40, v40
    v_rcp_f32 v41, v41
    v_rcp_f32 v42, v42
    v_rcp_f32 v43, v43
    v_rcp_f32 v44, v44
    v_rcp_f32 v45, v45
    v_rcp_f32 v46, v46
    v_rcp_f32 v47, v47
    s_nop 0
    v_mul_f32 v72, v40, v72
    v_mul_f32 v73, v41, v73
    v_mul_f32 v74, v42, v74
    v_mul_f32 v75, v43, v75
    v_mul_f32 v76, v44, v76
    v_mul_f32 v77, v45, v77
    v_mul_f32 v78, v46, v78
    v_mul_f32 v79, v47, v79
    v_cvt_pk_bf16_f32 v28, v72, v73
    v_cvt_pk_bf16_f32 v29, v74, v75
    v_cvt_pk_bf16_f32 v30, v76, v77
    v_cvt_pk_bf16_f32 v31, v78, v79
    v_mul_f32 v5, 0xbfb8aa3b, v19
    v_mul_f32 v40, v5, v88
    v_mul_f32 v41, v5, v89
    v_mul_f32 v42, v5, v90
    v_mul_f32 v43, v5, v91
    v_mul_f32 v44, v5, v92
    v_mul_f32 v45, v5, v93
    v_mul_f32 v46, v5, v94
    v_mul_f32 v47, v5, v95
    v_exp_f32 v40, v40
    v_exp_f32 v41, v41
    v_exp_f32 v42, v42
    v_exp_f32 v43, v43
    v_exp_f32 v44, v44
    v_exp_f32 v45, v45
    v_exp_f32 v46, v46
    v_exp_f32 v47, v47
    v_mul_f32 v88, v88, v96
    v_mul_f32 v89, v89, v97
    v_mul_f32 v90, v90, v98
    v_mul_f32 v91, v91, v99
    v_mul_f32 v92, v92, v100
    v_mul_f32 v93, v93, v101
    v_mul_f32 v94, v94, v102
    v_mul_f32 v95, v95, v103
    v_add_f32 v40, 1.0, v40
    v_add_f32 v41, 1.0, v41
    v_add_f32 v42, 1.0, v42
    v_add_f32 v43, 1.0, v43
    v_add_f32 v44, 1.0, v44
    v_add_f32 v45, 1.0, v45
    v_add_f32 v46, 1.0, v46
    v_add_f32 v47, 1.0, v47
    v_rcp_f32 v40, v40
    v_rcp_f32 v41, v41
    v_rcp_f32 v42, v42
    v_rcp_f32 v43, v43
    v_rcp_f32 v44, v44
    v_rcp_f32 v45, v45
    v_rcp_f32 v46, v46
    v_rcp_f32 v47, v47
    s_nop 0
    v_mul_f32 v88, v40, v88
    v_mul_f32 v89, v41, v89
    v_mul_f32 v90, v42, v90
    v_mul_f32 v91, v43, v91
    v_mul_f32 v92, v44, v92
    v_mul_f32 v93, v45, v93
    v_mul_f32 v94, v46, v94
    v_mul_f32 v95, v47, v95
    v_cvt_pk_bf16_f32 v32, v88, v89
    v_cvt_pk_bf16_f32 v33, v90, v91
    v_cvt_pk_bf16_f32 v34, v92, v93
    v_cvt_pk_bf16_f32 v35, v94, v95
    v_mul_f32 v40, v5, v104
    v_mul_f32 v41, v5, v105
    v_mul_f32 v42, v5, v106
    v_mul_f32 v43, v5, v107
    v_mul_f32 v44, v5, v108
    v_mul_f32 v45, v5, v109
    v_mul_f32 v46, v5, v110
    v_mul_f32 v47, v5, v111
    v_exp_f32 v40, v40
    v_exp_f32 v41, v41
    v_exp_f32 v42, v42
    v_exp_f32 v43, v43
    v_exp_f32 v44, v44
    v_exp_f32 v45, v45
    v_exp_f32 v46, v46
    v_exp_f32 v47, v47
    v_mul_f32 v104, v104, v112
    v_mul_f32 v105, v105, v113
    v_mul_f32 v106, v106, v114
    v_mul_f32 v107, v107, v115
    v_mul_f32 v108, v108, v116
    v_mul_f32 v109, v109, v117
    v_mul_f32 v110, v110, v118
    v_mul_f32 v111, v111, v119
    v_add_f32 v40, 1.0, v40
    v_add_f32 v41, 1.0, v41
    v_add_f32 v42, 1.0, v42
    v_add_f32 v43, 1.0, v43
    v_add_f32 v44, 1.0, v44
    v_add_f32 v45, 1.0, v45
    v_add_f32 v46, 1.0, v46
    v_add_f32 v47, 1.0, v47
    v_rcp_f32 v40, v40
    v_rcp_f32 v41, v41
    v_rcp_f32 v42, v42
    v_rcp_f32 v43, v43
    v_rcp_f32 v44, v44
    v_rcp_f32 v45, v45
    v_rcp_f32 v46, v46
    v_rcp_f32 v47, v47
    s_nop 0
    v_mul_f32 v104, v40, v104
    v_mul_f32 v105, v41, v105
    v_mul_f32 v106, v42, v106
    v_mul_f32 v107, v43, v107
    v_mul_f32 v108, v44, v108
    v_mul_f32 v109, v45, v109
    v_mul_f32 v110, v46, v110
    v_mul_f32 v111, v47, v111
    v_cvt_pk_bf16_f32 v36, v104, v105
    v_cvt_pk_bf16_f32 v37, v106, v107
    v_cvt_pk_bf16_f32 v38, v108, v109
    v_cvt_pk_bf16_f32 v39, v110, v111
    s_setprio 0
    s_mov_b32 s63, s60
    s_lshl_b32 s61, s29, 10
    s_lshl_b32 s62, s30, 7
    s_add_u32 s61, s61, s62
    s_add_u32 s61, s61, 0x2bc024
    s_mov_b32 s60, 6
PL_16:
    v_mov_b32 v7, 0
    buffer_load_dword v3, v7, s[24:27], 0 offen sc1
    buffer_load_dword v5, v7, s[8:11], s61 offen sc1
    s_waitcnt vmcnt(0)
    v_cmp_eq_u32 vcc, 0, v3
    v_cmp_ne_u32 s[64:65], v3, v5
    s_or_b64 vcc, vcc, s[64:65]
    s_cbranch_scc0 PD_15
    s_sleep 8
    s_sub_u32 s60, s60, 1
    s_cmp_lg_u32 s60, 0
    s_cbranch_scc1 PL_16
PD_15:
    s_mov_b32 s60, s63
    buffer_store_dwordx4 v[24:27], v4, s[8:11], s60 offen offset:0 sc1
    buffer_store_dwordx4 v[28:31], v4, s[8:11], s60 offen offset:512 sc1
    buffer_store_dwordx4 v[32:35], v4, s[8:11], s60 offen offset:2048 sc1
    buffer_store_dwordx4 v[36:39], v4, s[8:11], s60 offen offset:2560 sc1
F1_PUB:
    s_lshl_b32 s60, s70, 11
    s_lshr_b32 s61, s80, 1
    s_lshl_b32 s61, s61, 7
    s_add_u32 s60, s60, s61
    s_and_b32 s61, s80, 1
    s_lshl_b32 s61, s61, 4
    s_add_u32 s60, s60, s61
    s_and_b32 s61, s3, 3
    s_lshl_b32 s61, s61, 2
    s_add_u32 s60, s60, s61
    s_add_u32 s60, s60, 0x2b4000
    s_mov_b32 s66, 16384
    v_mov_b32 v7, 0
GL_17:
    s_waitcnt vmcnt(0)
    v_cmp_ne_u32 vcc, 0, v3
    s_nop 0
    s_cbranch_vccnz GK_18
    buffer_load_dword v3, v7, s[24:27], 0 offen sc1
    s_sub_u32 s66, s66, 1
    s_cmp_lg_u32 s66, 0
    s_cbranch_scc1 GL_17
GK_18:
    s_mov_b64 exec, 1
    buffer_store_dword v3, v7, s[8:11], s60 offen sc1
    s_mov_b64 exec, -1
F2_GO:
    s_setprio 0
    s_mov_b32 s20, s54
    s_mov_b32 s21, s55
    s_mov_b32 s22, 0x280000
    s_mov_b32 s23, 0x20000
    s_mul_i32 s72, s29, 81920
    s_mul_i32 s71, s30, 160
    s_add_u32 s72, s72, s71
    s_mul_i32 s73, s3, 10240
    s_lshl_b32 s76, s3, 10
    s_and_b32 s74, s3, 1
    s_lshr_b32 s75, s3, 1
    s_mul_i32 s71, s30, 378880
    s_add_u32 s71, s71, s76
    s_add_u32 s71, s71, 0x2d0000
    s_mul_i32 s70, s29, 74
    s_add_u32 s70, s70, s75
    s_lshl_b32 s70, s70, 1
    s_add_u32 s70, s70, s74
    s_lshl_b32 s70, s70, 11
    s_add_u32 s70, s70, 0x600000
    s_mul_i32 s61, s75, 5120
    v_add_u32 v5, s61, v2
    v_add_u32 v8, 40960, v5
    v_min_u32 v4, 53, v1
    v_lshrrev_b32 v6, 2, v4
    v_and_b32 v4, 3, v4
    v_lshlrev_b32 v4, 3, v4
    v_lshl_add_u32 v4, v6, 7, v4
    s_lshr_b32 s61, s29, 1
    s_lshl_b32 s61, s61, 11
    s_and_b32 s62, s29, 1
    s_lshl_b32 s62, s62, 2
    s_add_u32 s61, s61, s62
    s_add_u32 s61, s61, 0x2b4000
    v_lshlrev_b32 v9, 7, v1
    s_mov_b32 s62, 0x5b8000
    s_mov_b32 s63, 0x5ba000
    s_cmp_lg_u32 s3, 1
    s_cbranch_scc1 F2_NR
    s_mov_b32 s60, 16384
PL_20:
    v_mov_b32 v7, 0
    buffer_load_dword v3, v7, s[24:27], 0 offen sc1
    buffer_load_dword v16, v9, s[8:11], s62 offen sc1
    buffer_load_dword v17, v9, s[8:11], s63 offen sc1
    s_waitcnt vmcnt(0)
    v_cmp_eq_u32 vcc, 0, v3
    v_cmp_ne_u32 s[64:65], v3, v16
    s_or_b64 vcc, vcc, s[64:65]
    v_cmp_ne_u32 s[64:65], v3, v17
    s_or_b64 vcc, vcc, s[64:65]
    s_cbranch_scc0 PD_19
    s_sleep 24
    s_sub_u32 s60, s60, 1
    s_cmp_lg_u32 s60, 0
    s_cbranch_scc1 PL_20
PD_19:
F2_NR:
    s_cmp_lg_u32 s3, 0
    s_cbranch_scc1 PD_21
    s_mov_b32 s60, 16384
PL_22:
    v_mov_b32 v7, 0
    buffer_load_dword v3, v7, s[24:27], 0 offen sc1
    buffer_load_dword v6, v4, s[8:11], s61 offen sc1
    s_waitcnt vmcnt(0)
    v_cmp_eq_u32 vcc, 0, v3
    v_cmp_ne_u32 s[64:65], v3, v6
    s_or_b64 vcc, vcc, s[64:65]
    s_cbranch_scc0 PD_21
    s_sleep 16
    s_sub_u32 s60, s60, 1
    s_cmp_lg_u32 s60, 0
    s_cbranch_scc1 PL_22
PD_21:
    s_barrier
    s_setprio 0
    s_mul_i32 s60, s29, 74
    s_add_u32 s60, s60, 54
    s_lshl_b32 s60, s60, 12
    s_mul_i32 s61, s30, 10240
    s_add_u32 s60, s60, s61
    s_add_u32 s60, s60, s76
    s_add_u32 s60, s60, 0x600000
    v_mov_b32 v24, -1
    v_mov_b32 v25, -1
    v_mov_b32 v26, -1
    v_mov_b32 v27, -1
    buffer_store_dwordx4 v[24:27], v2, s[8:11], s60 offen sc1
    s_cmp_ge_u32 s3, 2
    s_cbranch_scc1 F2_NF
    s_add_u32 s60, s60, 8192
    buffer_store_dwordx4 v[24:27], v2, s[8:11], s60 offen sc1
F2_NF:
    s_add_u32 m0, s76, 0
    s_add_u32 s67, s71, 0
    buffer_load_dwordx4 v2, s[8:11], s67 offen sc1 lds
    s_add_u32 m0, s76, 8192
    s_add_u32 s67, s71, 8192
    buffer_load_dwordx4 v2, s[8:11], s67 offen sc1 lds
    s_cmp_ge_u32 s3, 4
    s_cbranch_scc1 F2D_23
    s_add_u32 m0, s76, 16384
    s_add_u32 s67, s71, 16384
    buffer_load_dwordx4 v2, s[8:11], s67 offen sc1 lds
F2D_23:
    buffer_load_dwordx4 v[16:19], v2, s[8:11], s70 offen offset:0 sc1
    buffer_load_dwordx4 v[20:23], v2, s[8:11], s70 offen offset:1024 sc1
    s_add_u32 s70, s70, 16384
    s_add_u32 m0, s76, 20480
    s_add_u32 s67, s71, 20480
    buffer_load_dwordx4 v2, s[8:11], s67 offen sc1 lds
    s_add_u32 m0, s76, 28672
    s_add_u32 s67, s71, 28672
    buffer_load_dwordx4 v2, s[8:11], s67 offen sc1 lds
    s_cmp_ge_u32 s3, 4
    s_cbranch_scc1 F2D_24
    s_add_u32 m0, s76, 36864
    s_add_u32 s67, s71, 36864
    buffer_load_dwordx4 v2, s[8:11], s67 offen sc1 lds
F2D_24:
    buffer_load_dwordx4 v[68:71], v2, s[8:11], s70 offen offset:0 sc1
    buffer_load_dwordx4 v[72:75], v2, s[8:11], s70 offen offset:1024 sc1
    s_add_u32 s70, s70, 16384
    s_add_u32 m0, s76, 40960
    s_add_u32 s67, s71, 40960
    buffer_load_dwordx4 v2, s[8:11], s67 offen sc1 lds
    s_add_u32 m0, s76, 49152
    s_add_u32 s67, s71, 49152
    buffer_load_dwordx4 v2, s[8:11], s67 offen sc1 lds
    s_cmp_ge_u32 s3, 4
    s_cbranch_scc1 F2D_25
    s_add_u32 m0, s76, 57344
    s_add_u32 s67, s71, 57344
    buffer_load_dwordx4 v2, s[8:11], s67 offen sc1 lds
F2D_25:
    buffer_load_dwordx4 v[76:79], v2, s[8:11], s70 offen offset:0 sc1
    buffer_load_dwordx4 v[80:83], v2, s[8:11], s70 offen offset:1024 sc1
    s_add_u32 s70, s70, 16384
    s_add_u32 m0, s76, 61440
    s_add_u32 s67, s71, 61440
    buffer_load_dwordx4 v2, s[8:11], s67 offen sc1 lds
    s_add_u32 m0, s76, 69632
    s_add_u32 s67, s71, 69632
    buffer_load_dwordx4 v2, s[8:11], s67 offen sc1 lds
    s_cmp_ge_u32 s3, 4
    s_cbranch_scc1 F2D_26
    s_add_u32 m0, s76, 77824
    s_add_u32 s67, s71, 77824
    buffer_load_dwordx4 v2, s[8:11], s67 offen sc1 lds
F2D_26:
    s_waitcnt vmcnt(12)
    s_barrier
    ds_read_b128 v[28:31], v5 offset:0
    ds_read_b128 v[32:35], v5 offset:1024
    ds_read_b128 v[36:39], v5 offset:2048
    ds_read_b128 v[40:43], v5 offset:3072
    ds_read_b128 v[44:47], v5 offset:4096
    s_cmp_lg_u32 s3, 0
    s_cbranch_scc1 F2_NG
    s_lshl_b32 s60, s29, 10
    s_lshl_b32 s61, s30, 7
    s_add_u32 s60, s60, s61
    s_add_u32 s60, s60, 0x2bc020
    v_mov_b32 v7, 0
    s_mov_b64 exec, 1
    buffer_store_dword v3, v7, s[8:11], s60 offen sc1
    s_mov_b64 exec, -1
F2_NG:
    s_waitcnt lgkmcnt(0) vmcnt(8)
    v_mfma_f32_16x16x32_bf16 v[88:91], v[28:31], v[16:19], 0
    v_mfma_f32_16x16x32_bf16 v[108:111], v[28:31], v[20:23], 0
    s_barrier
    ds_read_b128 v[48:51], v5 offset:20480
    ds_read_b128 v[52:55], v5 offset:21504
    ds_read_b128 v[56:59], v5 offset:22528
    v_mfma_f32_16x16x32_bf16 v[92:95], v[32:35], v[16:19], 0
    v_mfma_f32_16x16x32_bf16 v[112:115], v[32:35], v[20:23], 0
    ds_read_b128 v[60:63], v5 offset:23552
    ds_read_b128 v[64:67], v5 offset:24576
    v_mfma_f32_16x16x32_bf16 v[96:99], v[36:39], v[16:19], 0
    v_mfma_f32_16x16x32_bf16 v[116:119], v[36:39], v[20:23], 0
    s_add_u32 m0, s76, 0
    s_add_u32 s67, s71, 81920
    buffer_load_dwordx4 v2, s[8:11], s67 offen sc1 lds
    s_add_u32 m0, s76, 8192
    s_add_u32 s67, s71, 90112
    buffer_load_dwordx4 v2, s[8:11], s67 offen sc1 lds
    s_cmp_ge_u32 s3, 4
    s_cbranch_scc1 F2D_27
    s_add_u32 m0, s76, 16384
    s_add_u32 s67, s71, 98304
    buffer_load_dwordx4 v2, s[8:11], s67 offen sc1 lds
F2D_27:
    v_mfma_f32_16x16x32_bf16 v[100:103], v[40:43], v[16:19], 0
    v_mfma_f32_16x16x32_bf16 v[120:123], v[40:43], v[20:23], 0
    v_mfma_f32_16x16x32_bf16 v[104:107], v[44:47], v[16:19], 0
    v_mfma_f32_16x16x32_bf16 v[124:127], v[44:47], v[20:23], 0
    buffer_load_dwordx4 v[16:19], v2, s[8:11], s70 offen offset:0 sc1
    buffer_load_dwordx4 v[20:23], v2, s[8:11], s70 offen offset:1024 sc1
    s_add_u32 s70, s70, 16384
    s_waitcnt lgkmcnt(0) vmcnt(8)
    v_mfma_f32_16x16x32_bf16 v[88:91], v[48:51], v[68:71], v[88:91]
    v_mfma_f32_16x16x32_bf16 v[108:111], v[48:51], v[72:75], v[108:111]
    s_barrier
    ds_read_b128 v[28:31], v8 offset:0
    ds_read_b128 v[32:35], v8 offset:1024
    ds_read_b128 v[36:39], v8 offset:2048
    v_mfma_f32_16x16x32_bf16 v[92:95], v[52:55], v[68:71], v[92:95]
    v_mfma_f32_16x16x32_bf16 v[112:115], v[52:55], v[72:75], v[112:115]
    ds_read_b128 v[40:43], v8 offset:3072
    ds_read_b128 v[44:47], v8 offset:4096
    v_mfma_f32_16x16x32_bf16 v[96:99], v[56:59], v[68:71], v[96:99]
    v_mfma_f32_16x16x32_bf16 v[116:119], v[56:59], v[72:75], v[116:119]
    s_add_u32 m0, s76, 20480
    s_add_u32 s67, s71, 102400
    buffer_load_dwordx4 v2, s[8:11], s67 offen sc1 lds
    s_add_u32 m0, s76, 28672
    s_add_u32 s67, s71, 110592
    buffer_load_dwordx4 v2, s[8:11], s67 offen sc1 lds
    s_cmp_ge_u32 s3, 4
    s_cbranch_scc1 F2D_28
    s_add_u32 m0, s76, 36864
    s_add_u32 s67, s71, 118784
    buffer_load_dwordx4 v2, s[8:11], s67 offen sc1 lds
F2D_28:
    v_mfma_f32_16x16x32_bf16 v[100:103], v[60:63], v[68:71], v[100:103]
    v_mfma_f32_16x16x32_bf16 v[120:123], v[60:63], v[72:75], v[120:123]
    v_mfma_f32_16x16x32_bf16 v[104:107], v[64:67], v[68:71], v[104:107]
    v_mfma_f32_16x16x32_bf16 v[124:127], v[64:67], v[72:75], v[124:127]
    buffer_load_dwordx4 v[68:71], v2, s[8:11], s70 offen offset:0 sc1
    buffer_load_dwordx4 v[72:75], v2, s[8:11], s70 offen offset:1024 sc1
    s_add_u32 s70, s70, 16384
    s_waitcnt lgkmcnt(0) vmcnt(8)
    v_mfma_f32_16x16x32_bf16 v[88:91], v[28:31], v[76:79], v[88:91]
    v_mfma_f32_16x16x32_bf16 v[108:111], v[28:31], v[80:83], v[108:111]
    s_barrier
    ds_read_b128 v[48:51], v8 offset:20480
    ds_read_b128 v[52:55], v8 offset:21504
    ds_read_b128 v[56:59], v8 offset:22528
    v_mfma_f32_16x16x32_bf16 v[92:95], v[32:35], v[76:79], v[92:95]
    v_mfma_f32_16x16x32_bf16 v[112:115], v[32:35], v[80:83], v[112:115]
    ds_read_b128 v[60:63], v8 offset:23552
    ds_read_b128 v[64:67], v8 offset:24576
    v_mfma_f32_16x16x32_bf16 v[96:99], v[36:39], v[76:79], v[96:99]
    v_mfma_f32_16x16x32_bf16 v[116:119], v[36:39], v[80:83], v[116:119]
    s_add_u32 m0, s76, 40960
    s_add_u32 s67, s71, 122880
    buffer_load_dwordx4 v2, s[8:11], s67 offen sc1 lds
    s_add_u32 m0, s76, 49152
    s_add_u32 s67, s71, 131072
    buffer_load_dwordx4 v2, s[8:11], s67 offen sc1 lds
    s_cmp_ge_u32 s3, 4
    s_cbranch_scc1 F2D_29
    s_add_u32 m0, s76, 57344
    s_add_u32 s67, s71, 139264
    buffer_load_dwordx4 v2, s[8:11], s67 offen sc1 lds
F2D_29:
    v_mfma_f32_16x16x32_bf16 v[100:103], v[40:43], v[76:79], v[100:103]
    v_mfma_f32_16x16x32_bf16 v[120:123], v[40:43], v[80:83], v[120:123]
    v_mfma_f32_16x16x32_bf16 v[104:107], v[44:47], v[76:79], v[104:107]
    v_mfma_f32_16x16x32_bf16 v[124:127], v[44:47], v[80:83], v[124:127]
    buffer_load_dwordx4 v[76:79], v2, s[8:11], s70 offen offset:0 sc1
    buffer_load_dwordx4 v[80:83], v2, s[8:11], s70 offen offset:1024 sc1
    s_add_u32 s70, s70, 16384
    s_waitcnt lgkmcnt(0) vmcnt(8)
    v_mfma_f32_16x16x32_bf16 v[88:91], v[48:51], v[16:19], v[88:91]
    v_mfma_f32_16x16x32_bf16 v[108:111], v[48:51], v[20:23], v[108:111]
    s_barrier
    ds_read_b128 v[28:31], v5 offset:0
    ds_read_b128 v[32:35], v5 offset:1024
    ds_read_b128 v[36:39], v5 offset:2048
    v_mfma_f32_16x16x32_bf16 v[92:95], v[52:55], v[16:19], v[92:95]
    v_mfma_f32_16x16x32_bf16 v[112:115], v[52:55], v[20:23], v[112:115]
    ds_read_b128 v[40:43], v5 offset:3072
    ds_read_b128 v[44:47], v5 offset:4096
    v_mfma_f32_16x16x32_bf16 v[96:99], v[56:59], v[16:19], v[96:99]
    v_mfma_f32_16x16x32_bf16 v[116:119], v[56:59], v[20:23], v[116:119]
    s_add_u32 m0, s76, 61440
    s_add_u32 s67, s71, 143360
    buffer_load_dwordx4 v2, s[8:11], s67 offen sc1 lds
    s_add_u32 m0, s76, 69632
    s_add_u32 s67, s71, 151552
    buffer_load_dwordx4 v2, s[8:11], s67 offen sc1 lds
    s_cmp_ge_u32 s3, 4
    s_cbranch_scc1 F2D_30
    s_add_u32 m0, s76, 77824
    s_add_u32 s67, s71, 159744
    buffer_load_dwordx4 v2, s[8:11], s67 offen sc1 lds
F2D_30:
    v_mfma_f32_16x16x32_bf16 v[100:103], v[60:63], v[16:19], v[100:103]
    v_mfma_f32_16x16x32_bf16 v[120:123], v[60:63], v[20:23], v[120:123]
    v_mfma_f32_16x16x32_bf16 v[104:107], v[64:67], v[16:19], v[104:107]
    v_mfma_f32_16x16x32_bf16 v[124:127], v[64:67], v[20:23], v[124:127]
    buffer_load_dwordx4 v[16:19], v2, s[8:11], s70 offen offset:0 sc1
    buffer_load_dwordx4 v[20:23], v2, s[8:11], s70 offen offset:1024 sc1
    s_add_u32 s70, s70, 16384
    s_waitcnt lgkmcnt(0) vmcnt(8)
    v_mfma_f32_16x16x32_bf16 v[88:91], v[28:31], v[68:71], v[88:91]
    v_mfma_f32_16x16x32_bf16 v[108:111], v[28:31], v[72:75], v[108:111]
    s_barrier
    ds_read_b128 v[48:51], v5 offset:20480
    ds_read_b128 v[52:55], v5 offset:21504
    ds_read_b128 v[56:59], v5 offset:22528
    v_mfma_f32_16x16x32_bf16 v[92:95], v[32:35], v[68:71], v[92:95]
    v_mfma_f32_16x16x32_bf16 v[112:115], v[32:35], v[72:75], v[112:115]
    ds_read_b128 v[60:63], v5 offset:23552
    ds_read_b128 v[64:67], v5 offset:24576
    v_mfma_f32_16x16x32_bf16 v[96:99], v[36:39], v[68:71], v[96:99]
    v_mfma_f32_16x16x32_bf16 v[116:119], v[36:39], v[72:75], v[116:119]
    s_add_u32 m0, s76, 0
    s_add_u32 s67, s71, 163840
    buffer_load_dwordx4 v2, s[8:11], s67 offen sc1 lds
    s_add_u32 m0, s76, 8192
    s_add_u32 s67, s71, 172032
    buffer_load_dwordx4 v2, s[8:11], s67 offen sc1 lds
    s_cmp_ge_u32 s3, 4
    s_cbranch_scc1 F2D_31
    s_add_u32 m0, s76, 16384
    s_add_u32 s67, s71, 180224
    buffer_load_dwordx4 v2, s[8:11], s67 offen sc1 lds
F2D_31:
    v_mfma_f32_16x16x32_bf16 v[100:103], v[40:43], v[68:71], v[100:103]
    v_mfma_f32_16x16x32_bf16 v[120:123], v[40:43], v[72:75], v[120:123]
    v_mfma_f32_16x16x32_bf16 v[104:107], v[44:47], v[68:71], v[104:107]
    v_mfma_f32_16x16x32_bf16 v[124:127], v[44:47], v[72:75], v[124:127]
    buffer_load_dwordx4 v[68:71], v2, s[8:11], s70 offen offset:0 sc1
    buffer_load_dwordx4 v[72:75], v2, s[8:11], s70 offen offset:1024 sc1
    s_add_u32 s70, s70, 16384
    s_waitcnt lgkmcnt(0) vmcnt(8)
    v_mfma_f32_16x16x32_bf16 v[88:91], v[48:51], v[76:79], v[88:91]
    v_mfma_f32_16x16x32_bf16 v[108:111], v[48:51], v[80:83], v[108:111]
    s_barrier
    ds_read_b128 v[28:31], v8 offset:0
    ds_read_b128 v[32:35], v8 offset:1024
    ds_read_b128 v[36:39], v8 offset:2048
    v_mfma_f32_16x16x32_bf16 v[92:95], v[52:55], v[76:79], v[92:95]
    v_mfma_f32_16x16x32_bf16 v[112:115], v[52:55], v[80:83], v[112:115]
    ds_read_b128 v[40:43], v8 offset:3072
    ds_read_b128 v[44:47], v8 offset:4096
    v_mfma_f32_16x16x32_bf16 v[96:99], v[56:59], v[76:79], v[96:99]
    v_mfma_f32_16x16x32_bf16 v[116:119], v[56:59], v[80:83], v[116:119]
    s_add_u32 m0, s76, 20480
    s_add_u32 s67, s71, 184320
    buffer_load_dwordx4 v2, s[8:11], s67 offen sc1 lds
    s_add_u32 m0, s76, 28672
    s_add_u32 s67, s71, 192512
    buffer_load_dwordx4 v2, s[8:11], s67 offen sc1 lds
    s_cmp_ge_u32 s3, 4
    s_cbranch_scc1 F2D_32
    s_add_u32 m0, s76, 36864
    s_add_u32 s67, s71, 200704
    buffer_load_dwordx4 v2, s[8:11], s67 offen sc1 lds
F2D_32:
    v_mfma_f32_16x16x32_bf16 v[100:103], v[60:63], v[76:79], v[100:103]
    v_mfma_f32_16x16x32_bf16 v[120:123], v[60:63], v[80:83], v[120:123]
    v_mfma_f32_16x16x32_bf16 v[104:107], v[64:67], v[76:79], v[104:107]
    v_mfma_f32_16x16x32_bf16 v[124:127], v[64:67], v[80:83], v[124:127]
    buffer_load_dwordx4 v[76:79], v2, s[8:11], s70 offen offset:0 sc1
    buffer_load_dwordx4 v[80:83], v2, s[8:11], s70 offen offset:1024 sc1
    s_add_u32 s70, s70, 16384
    s_waitcnt lgkmcnt(0) vmcnt(8)
    v_mfma_f32_16x16x32_bf16 v[88:91], v[28:31], v[16:19], v[88:91]
    v_mfma_f32_16x16x32_bf16 v[108:111], v[28:31], v[20:23], v[108:111]
    s_barrier
    ds_read_b128 v[48:51], v8 offset:20480
    ds_read_b128 v[52:55], v8 offset:21504
    ds_read_b128 v[56:59], v8 offset:22528
    v_mfma_f32_16x16x32_bf16 v[92:95], v[32:35], v[16:19], v[92:95]
    v_mfma_f32_16x16x32_bf16 v[112:115], v[32:35], v[20:23], v[112:115]
    ds_read_b128 v[60:63], v8 offset:23552
    ds_read_b128 v[64:67], v8 offset:24576
    v_mfma_f32_16x16x32_bf16 v[96:99], v[36:39], v[16:19], v[96:99]
    v_mfma_f32_16x16x32_bf16 v[116:119], v[36:39], v[20:23], v[116:119]
    s_add_u32 m0, s76, 40960
    s_add_u32 s67, s71, 204800
    buffer_load_dwordx4 v2, s[8:11], s67 offen sc1 lds
    s_add_u32 m0, s76, 49152
    s_add_u32 s67, s71, 212992
    buffer_load_dwordx4 v2, s[8:11], s67 offen sc1 lds
    s_cmp_ge_u32 s3, 4
    s_cbranch_scc1 F2D_33
    s_add_u32 m0, s76, 57344
    s_add_u32 s67, s71, 221184
    buffer_load_dwordx4 v2, s[8:11], s67 offen sc1 lds
F2D_33:
    v_mfma_f32_16x16x32_bf16 v[100:103], v[40:43], v[16:19], v[100:103]
    v_mfma_f32_16x16x32_bf16 v[120:123], v[40:43], v[20:23], v[120:123]
    v_mfma_f32_16x16x32_bf16 v[104:107], v[44:47], v[16:19], v[104:107]
    v_mfma_f32_16x16x32_bf16 v[124:127], v[44:47], v[20:23], v[124:127]
    buffer_load_dwordx4 v[16:19], v2, s[8:11], s70 offen offset:0 sc1
    buffer_load_dwordx4 v[20:23], v2, s[8:11], s70 offen offset:1024 sc1
    s_add_u32 s70, s70, 16384
    s_waitcnt lgkmcnt(0) vmcnt(8)
    v_mfma_f32_16x16x32_bf16 v[88:91], v[48:51], v[68:71], v[88:91]
    v_mfma_f32_16x16x32_bf16 v[108:111], v[48:51], v[72:75], v[108:111]
    s_barrier
    ds_read_b128 v[28:31], v5 offset:0
    ds_read_b128 v[32:35], v5 offset:1024
    ds_read_b128 v[36:39], v5 offset:2048
    v_mfma_f32_16x16x32_bf16 v[92:95], v[52:55], v[68:71], v[92:95]
    v_mfma_f32_16x16x32_bf16 v[112:115], v[52:55], v[72:75], v[112:115]
    ds_read_b128 v[40:43], v5 offset:3072
    ds_read_b128 v[44:47], v5 offset:4096
    v_mfma_f32_16x16x32_bf16 v[96:99], v[56:59], v[68:71], v[96:99]
    v_mfma_f32_16x16x32_bf16 v[116:119], v[56:59], v[72:75], v[116:119]
    s_add_u32 m0, s76, 61440
    s_add_u32 s67, s71, 225280
    buffer_load_dwordx4 v2, s[8:11], s67 offen sc1 lds
    s_add_u32 m0, s76, 69632
    s_add_u32 s67, s71, 233472
    buffer_load_dwordx4 v2, s[8:11], s67 offen sc1 lds
    s_cmp_ge_u32 s3, 4
    s_cbranch_scc1 F2D_34
    s_add_u32 m0, s76, 77824
    s_add_u32 s67, s71, 241664
    buffer_load_dwordx4 v2, s[8:11], s67 offen sc1 lds
F2D_34:
    v_mfma_f32_16x16x32_bf16 v[100:103], v[60:63], v[68:71], v[100:103]
    v_mfma_f32_16x16x32_bf16 v[120:123], v[60:63], v[72:75], v[120:123]
    v_mfma_f32_16x16x32_bf16 v[104:107], v[64:67], v[68:71], v[104:107]
    v_mfma_f32_16x16x32_bf16 v[124:127], v[64:67], v[72:75], v[124:127]
    buffer_load_dwordx4 v[68:71], v2, s[8:11], s70 offen offset:0 sc1
    buffer_load_dwordx4 v[72:75], v2, s[8:11], s70 offen offset:1024 sc1
    s_add_u32 s70, s70, 16384
    s_waitcnt lgkmcnt(0) vmcnt(8)
    v_mfma_f32_16x16x32_bf16 v[88:91], v[28:31], v[76:79], v[88:91]
    v_mfma_f32_16x16x32_bf16 v[108:111], v[28:31], v[80:83], v[108:111]
    s_barrier
    ds_read_b128 v[48:51], v5 offset:20480
    ds_read_b128 v[52:55], v5 offset:21504
    ds_read_b128 v[56:59], v5 offset:22528
    v_mfma_f32_16x16x32_bf16 v[92:95], v[32:35], v[76:79], v[92:95]
    v_mfma_f32_16x16x32_bf16 v[112:115], v[32:35], v[80:83], v[112:115]
    ds_read_b128 v[60:63], v5 offset:23552
    ds_read_b128 v[64:67], v5 offset:24576
    v_mfma_f32_16x16x32_bf16 v[96:99], v[36:39], v[76:79], v[96:99]
    v_mfma_f32_16x16x32_bf16 v[116:119], v[36:39], v[80:83], v[116:119]
    s_add_u32 m0, s76, 0
    s_add_u32 s67, s71, 245760
    buffer_load_dwordx4 v2, s[8:11], s67 offen sc1 lds
    s_add_u32 m0, s76, 8192
    s_add_u32 s67, s71, 253952
    buffer_load_dwordx4 v2, s[8:11], s67 offen sc1 lds
    s_cmp_ge_u32 s3, 4
    s_cbranch_scc1 F2D_35
    s_add_u32 m0, s76, 16384
    s_add_u32 s67, s71, 262144
    buffer_load_dwordx4 v2, s[8:11], s67 offen sc1 lds
F2D_35:
    v_mfma_f32_16x16x32_bf16 v[100:103], v[40:43], v[76:79], v[100:103]
    v_mfma_f32_16x16x32_bf16 v[120:123], v[40:43], v[80:83], v[120:123]
    v_mfma_f32_16x16x32_bf16 v[104:107], v[44:47], v[76:79], v[104:107]
    v_mfma_f32_16x16x32_bf16 v[124:127], v[44:47], v[80:83], v[124:127]
    buffer_load_dwordx4 v[76:79], v2, s[8:11], s70 offen offset:0 sc1
    buffer_load_dwordx4 v[80:83], v2, s[8:11], s70 offen offset:1024 sc1
    s_add_u32 s70, s70, 16384
    s_waitcnt lgkmcnt(0) vmcnt(8)
    v_mfma_f32_16x16x32_bf16 v[88:91], v[48:51], v[16:19], v[88:91]
    v_mfma_f32_16x16x32_bf16 v[108:111], v[48:51], v[20:23], v[108:111]
    s_barrier
    ds_read_b128 v[28:31], v8 offset:0
    ds_read_b128 v[32:35], v8 offset:1024
    ds_read_b128 v[36:39], v8 offset:2048
    v_mfma_f32_16x16x32_bf16 v[92:95], v[52:55], v[16:19], v[92:95]
    v_mfma_f32_16x16x32_bf16 v[112:115], v[52:55], v[20:23], v[112:115]
    ds_read_b128 v[40:43], v8 offset:3072
    ds_read_b128 v[44:47], v8 offset:4096
    v_mfma_f32_16x16x32_bf16 v[96:99], v[56:59], v[16:19], v[96:99]
    v_mfma_f32_16x16x32_bf16 v[116:119], v[56:59], v[20:23], v[116:119]
    s_add_u32 m0, s76, 20480
    s_add_u32 s67, s71, 266240
    buffer_load_dwordx4 v2, s[8:11], s67 offen sc1 lds
    s_add_u32 m0, s76, 28672
    s_add_u32 s67, s71, 274432
    buffer_load_dwordx4 v2, s[8:11], s67 offen sc1 lds
    s_cmp_ge_u32 s3, 4
    s_cbranch_scc1 F2D_36
    s_add_u32 m0, s76, 36864
    s_add_u32 s67, s71, 282624
    buffer_load_dwordx4 v2, s[8:11], s67 offen sc1 lds
F2D_36:
    v_mfma_f32_16x16x32_bf16 v[100:103], v[60:63], v[16:19], v[100:103]
    v_mfma_f32_16x16x32_bf16 v[120:123], v[60:63], v[20:23], v[120:123]
    v_mfma_f32_16x16x32_bf16 v[104:107], v[64:67], v[16:19], v[104:107]
    v_mfma_f32_16x16x32_bf16 v[124:127], v[64:67], v[20:23], v[124:127]
    buffer_load_dwordx4 v[16:19], v2, s[8:11], s70 offen offset:0 sc1
    buffer_load_dwordx4 v[20:23], v2, s[8:11], s70 offen offset:1024 sc1
    s_add_u32 s70, s70, 16384
    s_waitcnt lgkmcnt(0) vmcnt(8)
    v_mfma_f32_16x16x32_bf16 v[88:91], v[28:31], v[68:71], v[88:91]
    v_mfma_f32_16x16x32_bf16 v[108:111], v[28:31], v[72:75], v[108:111]
    s_barrier
    ds_read_b128 v[48:51], v8 offset:20480
    ds_read_b128 v[52:55], v8 offset:21504
    ds_read_b128 v[56:59], v8 offset:22528
    v_mfma_f32_16x16x32_bf16 v[92:95], v[32:35], v[68:71], v[92:95]
    v_mfma_f32_16x16x32_bf16 v[112:115], v[32:35], v[72:75], v[112:115]
    ds_read_b128 v[60:63], v8 offset:23552
    ds_read_b128 v[64:67], v8 offset:24576
    v_mfma_f32_16x16x32_bf16 v[96:99], v[36:39], v[68:71], v[96:99]
    v_mfma_f32_16x16x32_bf16 v[116:119], v[36:39], v[72:75], v[116:119]
    s_add_u32 m0, s76, 40960
    s_add_u32 s67, s71, 276480
    buffer_load_dwordx4 v2, s[8:11], s67 offen sc1 lds
    s_add_u32 m0, s76, 49152
    s_add_u32 s67, s71, 284672
    buffer_load_dwordx4 v2, s[8:11], s67 offen sc1 lds
    s_cmp_ge_u32 s3, 4
    s_cbranch_scc1 F2D_37
    s_add_u32 m0, s76, 57344
    s_add_u32 s67, s71, 292864
    buffer_load_dwordx4 v2, s[8:11], s67 offen sc1 lds
F2D_37:
    v_mfma_f32_16x16x32_bf16 v[100:103], v[40:43], v[68:71], v[100:103]
    v_mfma_f32_16x16x32_bf16 v[120:123], v[40:43], v[72:75], v[120:123]
    v_mfma_f32_16x16x32_bf16 v[104:107], v[44:47], v[68:71], v[104:107]
    v_mfma_f32_16x16x32_bf16 v[124:127], v[44:47], v[72:75], v[124:127]
    buffer_load_dwordx4 v[68:71], v2, s[8:11], s70 offen offset:0 sc1
    buffer_load_dwordx4 v[72:75], v2, s[8:11], s70 offen offset:1024 sc1
    s_add_u32 s70, s70, 16384
    s_waitcnt lgkmcnt(0) vmcnt(8)
    v_mfma_f32_16x16x32_bf16 v[88:91], v[48:51], v[76:79], v[88:91]
    v_mfma_f32_16x16x32_bf16 v[108:111], v[48:51], v[80:83], v[108:111]
    s_barrier
    ds_read_b128 v[28:31], v5 offset:0
    ds_read_b128 v[32:35], v5 offset:1024
    ds_read_b128 v[36:39], v5 offset:2048
    v_mfma_f32_16x16x32_bf16 v[92:95], v[52:55], v[76:79], v[92:95]
    v_mfma_f32_16x16x32_bf16 v[112:115], v[52:55], v[80:83], v[112:115]
    ds_read_b128 v[40:43], v5 offset:3072
    ds_read_b128 v[44:47], v5 offset:4096
    v_mfma_f32_16x16x32_bf16 v[96:99], v[56:59], v[76:79], v[96:99]
    v_mfma_f32_16x16x32_bf16 v[116:119], v[56:59], v[80:83], v[116:119]
    v_mfma_f32_16x16x32_bf16 v[100:103], v[60:63], v[76:79], v[100:103]
    v_mfma_f32_16x16x32_bf16 v[120:123], v[60:63], v[80:83], v[120:123]
    v_mfma_f32_16x16x32_bf16 v[104:107], v[64:67], v[76:79], v[104:107]
    v_mfma_f32_16x16x32_bf16 v[124:127], v[64:67], v[80:83], v[124:127]
    s_waitcnt lgkmcnt(0) vmcnt(4)
    v_mfma_f32_16x16x32_bf16 v[88:91], v[28:31], v[16:19], v[88:91]
    v_mfma_f32_16x16x32_bf16 v[108:111], v[28:31], v[20:23], v[108:111]
    s_barrier
    ds_read_b128 v[48:51], v5 offset:20480
    ds_read_b128 v[52:55], v5 offset:21504
    ds_read_b128 v[56:59], v5 offset:22528
    v_mfma_f32_16x16x32_bf16 v[92:95], v[32:35], v[16:19], v[92:95]
    v_mfma_f32_16x16x32_bf16 v[112:115], v[32:35], v[20:23], v[112:115]
    ds_read_b128 v[60:63], v5 offset:23552
    ds_read_b128 v[64:67], v5 offset:24576
    v_mfma_f32_16x16x32_bf16 v[96:99], v[36:39], v[16:19], v[96:99]
    v_mfma_f32_16x16x32_bf16 v[116:119], v[36:39], v[20:23], v[116:119]
    v_mfma_f32_16x16x32_bf16 v[100:103], v[40:43], v[16:19], v[100:103]
    v_mfma_f32_16x16x32_bf16 v[120:123], v[40:43], v[20:23], v[120:123]
    v_mfma_f32_16x16x32_bf16 v[104:107], v[44:47], v[16:19], v[104:107]
    v_mfma_f32_16x16x32_bf16 v[124:127], v[44:47], v[20:23], v[124:127]
    s_waitcnt lgkmcnt(0) vmcnt(0)
    s_barrier
    ds_read_b128 v[28:31], v8 offset:0
    ds_read_b128 v[32:35], v8 offset:1024
    ds_read_b128 v[36:39], v8 offset:2048
    ds_read_b128 v[40:43], v8 offset:3072
    ds_read_b128 v[44:47], v8 offset:4096
    s_cmp_ge_u32 s75, 2
    s_cbranch_scc1 F2_X
    v_mfma_f32_16x16x32_bf16 v[88:91], v[48:51], v[68:71], v[88:91]
    v_mfma_f32_16x16x32_bf16 v[108:111], v[48:51], v[72:75], v[108:111]
    v_mfma_f32_16x16x32_bf16 v[92:95], v[52:55], v[68:71], v[92:95]
    v_mfma_f32_16x16x32_bf16 v[112:115], v[52:55], v[72:75], v[112:115]
    v_mfma_f32_16x16x32_bf16 v[96:99], v[56:59], v[68:71], v[96:99]
    v_mfma_f32_16x16x32_bf16 v[116:119], v[56:59], v[72:75], v[116:119]
    v_mfma_f32_16x16x32_bf16 v[100:103], v[60:63], v[68:71], v[100:103]
    v_mfma_f32_16x16x32_bf16 v[120:123], v[60:63], v[72:75], v[120:123]
    v_mfma_f32_16x16x32_bf16 v[104:107], v[64:67], v[68:71], v[104:107]
    v_mfma_f32_16x16x32_bf16 v[124:127], v[64:67], v[72:75], v[124:127]
F2_X:
    s_setprio 0
    v_and_b32 v6, 15, v1
    v_mul_u32_u24 v4, 1280, v6
    v_lshrrev_b32 v7, 4, v1
    v_lshl_add_u32 v4, v7, 3, v4
    v_lshlrev_b32 v6, 3, v6
    s_lshl_b32 s64, s29, 9
    s_add_u32 s64, s64, 0x2a9004
    s_add_u32 s60, s3, 0
    s_min_u32 s60, s60, 19
    s_mul_hi_u32 s61, s60, 0x33333334
    s_mul_i32 s62, s61, 5
    s_sub_u32 s62, s60, s62
    s_mul_i32 s63, s61, 20480
    s_lshl_b32 s62, s62, 5
    s_add_u32 s63, s63, s62
    v_add_u32 v11, s63, v4
    s_lshl_b32 s61, s61, 7
    s_add_u32 s61, s61, s64
    buffer_load_dword v14, v6, s[8:11], s61 offen sc1
    s_add_u32 s60, s3, 8
    s_min_u32 s60, s60, 19
    s_mul_hi_u32 s61, s60, 0x33333334
    s_mul_i32 s62, s61, 5
    s_sub_u32 s62, s60, s62
    s_mul_i32 s63, s61, 20480
    s_lshl_b32 s62, s62, 5
    s_add_u32 s63, s63, s62
    v_add_u32 v12, s63, v4
    s_lshl_b32 s61, s61, 7
    s_add_u32 s61, s61, s64
    buffer_load_dword v15, v6, s[8:11], s61 offen sc1
    s_add_u32 s60, s3, 16
    s_min_u32 s60, s60, 19
    s_mul_hi_u32 s61, s60, 0x33333334
    s_mul_i32 s62, s61, 5
    s_sub_u32 s62, s60, s62
    s_mul_i32 s63, s61, 20480
    s_lshl_b32 s62, s62, 5
    s_add_u32 s63, s63, s62
    v_add_u32 v13, s63, v4
    s_lshl_b32 s61, s61, 7
    s_add_u32 s61, s61, s64
    buffer_load_dword v16, v6, s[8:11], s61 offen sc1
    buffer_load_dwordx2 v[20:21], v11, s[12:15], s72 offen
    buffer_load_dwordx2 v[22:23], v12, s[12:15], s72 offen
    buffer_load_dwordx2 v[24:25], v13, s[12:15], s72 offen
    s_mul_i32 s70, s29, 74
    s_add_u32 s70, s70, s75
    s_add_u32 s70, s70, 54
    s_lshl_b32 s70, s70, 1
    s_add_u32 s70, s70, s74
    s_lshl_b32 s70, s70, 11
    s_add_u32 s70, s70, 0x600000
    v_add_u32 v4, s76, v2
    v_add_u32 v6, 16384, v4
    v_add_u32 v7, s73, v2
    s_waitcnt lgkmcnt(0)
    s_barrier
    s_nop 4
    ds_write_b128 v7, v[88:91] offset:0
    ds_write_b128 v7, v[92:95] offset:1024
    ds_write_b128 v7, v[96:99] offset:2048
    ds_write_b128 v7, v[100:103] offset:3072
    ds_write_b128 v7, v[104:107] offset:4096
    ds_write_b128 v7, v[108:111] offset:5120
    ds_write_b128 v7, v[112:115] offset:6144
    ds_write_b128 v7, v[116:119] offset:7168
    ds_write_b128 v7, v[120:123] offset:8192
    ds_write_b128 v7, v[124:127] offset:9216
    s_waitcnt lgkmcnt(0)
    s_barrier
    ds_read_b128 v[48:51], v4 offset:0
    ds_read_b128 v[52:55], v4 offset:20480
    ds_read_b128 v[56:59], v4 offset:40960
    ds_read_b128 v[60:63], v4 offset:61440
    ds_read_b128 v[64:67], v4 offset:8192
    ds_read_b128 v[68:71], v4 offset:28672
    ds_read_b128 v[72:75], v4 offset:49152
    ds_read_b128 v[76:79], v6 offset:53248
    ds_read_b128 v[80:83], v6 offset:0
    ds_read_b128 v[84:87], v6 offset:20480
    ds_read_b128 v[88:91], v6 offset:40960
    ds_read_b128 v[92:95], v6 offset:61440
    s_waitcnt lgkmcnt(0)
    s_barrier
    s_add_u32 m0, s76, 0
    s_add_u32 s67, s71, 296960
    buffer_load_dwordx4 v2, s[8:11], s67 offen sc1 lds
    s_add_u32 m0, s76, 8192
    s_add_u32 s67, s71, 305152
    buffer_load_dwordx4 v2, s[8:11], s67 offen sc1 lds
    s_cmp_ge_u32 s3, 4
    s_cbranch_scc1 F2D_38
    s_add_u32 m0, s76, 16384
    s_add_u32 s67, s71, 313344
    buffer_load_dwordx4 v2, s[8:11], s67 offen sc1 lds
F2D_38:
    s_add_u32 m0, s76, 20480
    s_add_u32 s67, s71, 317440
    buffer_load_dwordx4 v2, s[8:11], s67 offen sc1 lds
    s_add_u32 m0, s76, 28672
    s_add_u32 s67, s71, 325632
    buffer_load_dwordx4 v2, s[8:11], s67 offen sc1 lds
    s_cmp_ge_u32 s3, 4
    s_cbranch_scc1 F2D_39
    s_add_u32 m0, s76, 36864
    s_add_u32 s67, s71, 333824
    buffer_load_dwordx4 v2, s[8:11], s67 offen sc1 lds
F2D_39:
    s_add_u32 m0, s76, 40960
    s_add_u32 s67, s71, 337920
    buffer_load_dwordx4 v2, s[8:11], s67 offen sc1 lds
    s_add_u32 m0, s76, 49152
    s_add_u32 s67, s71, 346112
    buffer_load_dwordx4 v2, s[8:11], s67 offen sc1 lds
    s_cmp_ge_u32 s3, 4
    s_cbranch_scc1 F2D_40
    s_add_u32 m0, s76, 57344
    s_add_u32 s67, s71, 354304
    buffer_load_dwordx4 v2, s[8:11], s67 offen sc1 lds
F2D_40:
    s_add_u32 m0, s76, 61440
    s_add_u32 s67, s71, 358400
    buffer_load_dwordx4 v2, s[8:11], s67 offen sc1 lds
    s_add_u32 m0, s76, 69632
    s_add_u32 s67, s71, 366592
    buffer_load_dwordx4 v2, s[8:11], s67 offen sc1 lds
    s_cmp_ge_u32 s3, 4
    s_cbranch_scc1 F2D_41
    s_add_u32 m0, s76, 77824
    s_add_u32 s67, s71, 374784
    buffer_load_dwordx4 v2, s[8:11], s67 offen sc1 lds
F2D_41:
    v_add_f32 v48, v48, v52
    v_add_f32 v49, v49, v53
    v_add_f32 v50, v50, v54
    v_add_f32 v51, v51, v55
    v_add_f32 v56, v56, v60
    v_add_f32 v57, v57, v61
    v_add_f32 v58, v58, v62
    v_add_f32 v59, v59, v63
    v_add_f32 v48, v48, v56
    v_add_f32 v49, v49, v57
    v_add_f32 v50, v50, v58
    v_add_f32 v51, v51, v59
    v_add_f32 v64, v64, v68
    v_add_f32 v65, v65, v69
    v_add_f32 v66, v66, v70
    v_add_f32 v67, v67, v71
    v_add_f32 v72, v72, v76
    v_add_f32 v73, v73, v77
    v_add_f32 v74, v74, v78
    v_add_f32 v75, v75, v79
    v_add_f32 v64, v64, v72
    v_add_f32 v65, v65, v73
    v_add_f32 v66, v66, v74
    v_add_f32 v67, v67, v75
    v_add_f32 v80, v80, v84
    v_add_f32 v81, v81, v85
    v_add_f32 v82, v82, v86
    v_add_f32 v83, v83, v87
    v_add_f32 v88, v88, v92
    v_add_f32 v89, v89, v93
    v_add_f32 v90, v90, v94
    v_add_f32 v91, v91, v95
    v_add_f32 v80, v80, v88
    v_add_f32 v81, v81, v89
    v_add_f32 v82, v82, v90
    v_add_f32 v83, v83, v91
    s_setprio 0
    s_waitcnt vmcnt(8)
    v_mul_f32 v14, v14, v14
    v_mul_f32 v15, v15, v15
    v_mul_f32 v16, v16, v16
    v_mul_f32 v48, v14, v48
    v_mul_f32 v49, v14, v49
    v_mul_f32 v50, v14, v50
    v_mul_f32 v51, v14, v51
    v_mul_f32 v64, v15, v64
    v_mul_f32 v65, v15, v65
    v_mul_f32 v66, v15, v66
    v_mul_f32 v67, v15, v67
    v_mul_f32 v80, v16, v80
    v_mul_f32 v81, v16, v81
    v_mul_f32 v82, v16, v82
    v_mul_f32 v83, v16, v83
    v_mul_f32 v96, 0xbfb8aa3b, v48
    v_mul_f32 v97, 0xbfb8aa3b, v49
    v_mul_f32 v98, 0xbfb8aa3b, v50
    v_mul_f32 v99, 0xbfb8aa3b, v51
    v_mul_f32 v100, 0xbfb8aa3b, v64
    v_mul_f32 v101, 0xbfb8aa3b, v65
    v_mul_f32 v102, 0xbfb8aa3b, v66
    v_mul_f32 v103, 0xbfb8aa3b, v67
    v_mul_f32 v104, 0xbfb8aa3b, v80
    v_mul_f32 v105, 0xbfb8aa3b, v81
    v_mul_f32 v106, 0xbfb8aa3b, v82
    v_mul_f32 v107, 0xbfb8aa3b, v83
    v_exp_f32 v96, v96
    v_exp_f32 v97, v97
    v_exp_f32 v98, v98
    v_exp_f32 v99, v99
    v_exp_f32 v100, v100
    v_exp_f32 v101, v101
    v_exp_f32 v102, v102
    v_exp_f32 v103, v103
    v_exp_f32 v104, v104
    v_exp_f32 v105, v105
    v_exp_f32 v106, v106
    v_exp_f32 v107, v107
    s_nop 0
    v_add_f32 v96, 1.0, v96
    v_add_f32 v97, 1.0, v97
    v_add_f32 v98, 1.0, v98
    v_add_f32 v99, 1.0, v99
    v_add_f32 v100, 1.0, v100
    v_add_f32 v101, 1.0, v101
    v_add_f32 v102, 1.0, v102
    v_add_f32 v103, 1.0, v103
    v_add_f32 v104, 1.0, v104
    v_add_f32 v105, 1.0, v105
    v_add_f32 v106, 1.0, v106
    v_add_f32 v107, 1.0, v107
    v_rcp_f32 v96, v96
    v_rcp_f32 v97, v97
    v_rcp_f32 v98, v98
    v_rcp_f32 v99, v99
    v_rcp_f32 v100, v100
    v_rcp_f32 v101, v101
    v_rcp_f32 v102, v102
    v_rcp_f32 v103, v103
    v_rcp_f32 v104, v104
    v_rcp_f32 v105, v105
    v_rcp_f32 v106, v106
    v_rcp_f32 v107, v107
    s_nop 0
    v_mul_f32 v96, v96, v48
    v_mul_f32 v97, v97, v49
    v_mul_f32 v98, v98, v50
    v_mul_f32 v99, v99, v51
    v_mul_f32 v100, v100, v64
    v_mul_f32 v101, v101, v65
    v_mul_f32 v102, v102, v66
    v_mul_f32 v103, v103, v67
    v_mul_f32 v104, v104, v80
    v_mul_f32 v105, v105, v81
    v_mul_f32 v106, v106, v82
    v_mul_f32 v107, v107, v83
    v_cvt_pk_bf16_f32 v14, v96, v97
    v_cvt_pk_bf16_f32 v15, v98, v99
    v_cvt_pk_bf16_f32 v16, v100, v101
    v_cvt_pk_bf16_f32 v17, v102, v103
    v_cvt_pk_bf16_f32 v18, v104, v105
    v_cvt_pk_bf16_f32 v19, v106, v107
    s_setprio 0
    v_bfe_u32 v7, v1, 2, 3
    v_and_b32 v26, 3, v1
    v_lshlrev_b32 v26, 3, v26
    v_lshl_add_u32 v26, v7, 7, v26
    s_lshl_b32 s61, s29, 10
    s_lshl_b32 s62, s74, 2
    s_add_u32 s61, s61, s62
    s_add_u32 s61, s61, 0x2bc000
    s_waitcnt vmcnt(0)
    v_lshrrev_b32 v7, 3, v1
    v_and_b32 v26, 7, v1
    v_lshlrev_b32 v26, 2, v26
    v_lshl_add_u32 v26, v7, 7, v26
    s_cmp_lg_u32 s3, 0
    s_cbranch_scc1 PD_42
    s_mov_b32 s60, 16384
PL_43:
    v_mov_b32 v7, 0
    buffer_load_dword v3, v7, s[24:27], 0 offen sc1
    buffer_load_dword v27, v26, s[8:11], s61 offen sc1
    s_waitcnt vmcnt(0)
    v_cmp_eq_u32 vcc, 0, v3
    v_cmp_ne_u32 s[64:65], v3, v27
    s_or_b64 vcc, vcc, s[64:65]
    s_cbranch_scc0 PD_42
    s_sleep 2
    s_sub_u32 s60, s60, 1
    s_cmp_lg_u32 s60, 0
    s_cbranch_scc1 PL_43
PD_42:
    s_barrier
    s_mov_b32 s62, 16384
F3_PL:
    s_mov_b32 s60, s70
    buffer_load_dwordx4 v[48:51], v2, s[8:11], s60 offen offset:0 sc1
    buffer_load_dwordx4 v[52:55], v2, s[8:11], s60 offen offset:1024 sc1
    s_add_u32 s60, s60, 16384
    buffer_load_dwordx4 v[56:59], v2, s[8:11], s60 offen offset:0 sc1
    buffer_load_dwordx4 v[60:63], v2, s[8:11], s60 offen offset:1024 sc1
    s_add_u32 s60, s60, 16384
    buffer_load_dwordx4 v[64:67], v2, s[8:11], s60 offen offset:0 sc1
    buffer_load_dwordx4 v[68:71], v2, s[8:11], s60 offen offset:1024 sc1
    s_add_u32 s60, s60, 16384
    buffer_load_dwordx4 v[72:75], v2, s[8:11], s60 offen offset:0 sc1
    buffer_load_dwordx4 v[76:79], v2, s[8:11], s60 offen offset:1024 sc1
    s_add_u32 s60, s60, 16384
    buffer_load_dwordx4 v[80:83], v2, s[8:11], s60 offen offset:0 sc1
    buffer_load_dwordx4 v[84:87], v2, s[8:11], s60 offen offset:1024 sc1
    s_add_u32 s60, s60, 16384
    s_waitcnt vmcnt(8)
    v_max_u32 v27, v48, v49
    v_max3_u32 v27, v27, v50, v51
    v_max3_u32 v27, v27, v52, v53
    v_max3_u32 v27, v27, v54, v55
    s_waitcnt vmcnt(6)
    v_max3_u32 v27, v27, v56, v57
    v_max3_u32 v27, v27, v58, v59
    v_max3_u32 v27, v27, v60, v61
    v_max3_u32 v27, v27, v62, v63
    s_waitcnt vmcnt(4)
    v_max3_u32 v27, v27, v64, v65
    v_max3_u32 v27, v27, v66, v67
    v_max3_u32 v27, v27, v68, v69
    v_max3_u32 v27, v27, v70, v71
    s_waitcnt vmcnt(2)
    v_max3_u32 v27, v27, v72, v73
    v_max3_u32 v27, v27, v74, v75
    v_max3_u32 v27, v27, v76, v77
    v_max3_u32 v27, v27, v78, v79
    s_waitcnt vmcnt(0)
    v_max3_u32 v27, v27, v80, v81
    v_max3_u32 v27, v27, v82, v83
    v_max3_u32 v27, v27, v84, v85
    v_max3_u32 v27, v27, v86, v87
    v_cmp_eq_u32 vcc, -1, v27
    s_sub_u32 s62, s62, 1
    s_cbranch_scc1 F3_GO
    s_cbranch_vccnz F3_PL
F3_GO:
    s_setprio 3
    v_mfma_f32_16x16x32_bf16 v[88:91], v[28:31], v[48:51], 0
    v_mfma_f32_16x16x32_bf16 v[108:111], v[28:31], v[52:55], 0
    ds_read_b128 v[28:31], v5 offset:0
    v_mfma_f32_16x16x32_bf16 v[92:95], v[32:35], v[48:51], 0
    v_mfma_f32_16x16x32_bf16 v[112:115], v[32:35], v[52:55], 0
    ds_read_b128 v[32:35], v5 offset:1024
    v_mfma_f32_16x16x32_bf16 v[96:99], v[36:39], v[48:51], 0
    v_mfma_f32_16x16x32_bf16 v[116:119], v[36:39], v[52:55], 0
    ds_read_b128 v[36:39], v5 offset:2048
    v_mfma_f32_16x16x32_bf16 v[100:103], v[40:43], v[48:51], 0
    v_mfma_f32_16x16x32_bf16 v[120:123], v[40:43], v[52:55], 0
    ds_read_b128 v[40:43], v5 offset:3072
    v_mfma_f32_16x16x32_bf16 v[104:107], v[44:47], v[48:51], 0
    v_mfma_f32_16x16x32_bf16 v[124:127], v[44:47], v[52:55], 0
    ds_read_b128 v[44:47], v5 offset:4096
    s_waitcnt lgkmcnt(4)
    v_mfma_f32_16x16x32_bf16 v[88:91], v[28:31], v[56:59], v[88:91]
    v_mfma_f32_16x16x32_bf16 v[108:111], v[28:31], v[60:63], v[108:111]
    ds_read_b128 v[28:31], v5 offset:20480
    s_waitcnt lgkmcnt(4)
    v_mfma_f32_16x16x32_bf16 v[92:95], v[32:35], v[56:59], v[92:95]
    v_mfma_f32_16x16x32_bf16 v[112:115], v[32:35], v[60:63], v[112:115]
    ds_read_b128 v[32:35], v5 offset:21504
    s_waitcnt lgkmcnt(4)
    v_mfma_f32_16x16x32_bf16 v[96:99], v[36:39], v[56:59], v[96:99]
    v_mfma_f32_16x16x32_bf16 v[116:119], v[36:39], v[60:63], v[116:119]
    ds_read_b128 v[36:39], v5 offset:22528
    s_waitcnt lgkmcnt(4)
    v_mfma_f32_16x16x32_bf16 v[100:103], v[40:43], v[56:59], v[100:103]
    v_mfma_f32_16x16x32_bf16 v[120:123], v[40:43], v[60:63], v[120:123]
    ds_read_b128 v[40:43], v5 offset:23552
    s_waitcnt lgkmcnt(4)
    v_mfma_f32_16x16x32_bf16 v[104:107], v[44:47], v[56:59], v[104:107]
    v_mfma_f32_16x16x32_bf16 v[124:127], v[44:47], v[60:63], v[124:127]
    ds_read_b128 v[44:47], v5 offset:24576
    s_waitcnt lgkmcnt(4)
    v_mfma_f32_16x16x32_bf16 v[88:91], v[28:31], v[64:67], v[88:91]
    v_mfma_f32_16x16x32_bf16 v[108:111], v[28:31], v[68:71], v[108:111]
    ds_read_b128 v[28:31], v8 offset:0
    s_waitcnt lgkmcnt(4)
    v_mfma_f32_16x16x32_bf16 v[92:95], v[32:35], v[64:67], v[92:95]
    v_mfma_f32_16x16x32_bf16 v[112:115], v[32:35], v[68:71], v[112:115]
    ds_read_b128 v[32:35], v8 offset:1024
    s_waitcnt lgkmcnt(4)
    v_mfma_f32_16x16x32_bf16 v[96:99], v[36:39], v[64:67], v[96:99]
    v_mfma_f32_16x16x32_bf16 v[116:119], v[36:39], v[68:71], v[116:119]
    ds_read_b128 v[36:39], v8 offset:2048
    s_waitcnt lgkmcnt(4)
    v_mfma_f32_16x16x32_bf16 v[100:103], v[40:43], v[64:67], v[100:103]
    v_mfma_f32_16x16x32_bf16 v[120:123], v[40:43], v[68:71], v[120:123]
    ds_read_b128 v[40:43], v8 offset:3072
    s_waitcnt lgkmcnt(4)
    v_mfma_f32_16x16x32_bf16 v[104:107], v[44:47], v[64:67], v[104:107]
    v_mfma_f32_16x16x32_bf16 v[124:127], v[44:47], v[68:71], v[124:127]
    ds_read_b128 v[44:47], v8 offset:4096
    s_waitcnt lgkmcnt(4)
    v_mfma_f32_16x16x32_bf16 v[88:91], v[28:31], v[72:75], v[88:91]
    v_mfma_f32_16x16x32_bf16 v[108:111], v[28:31], v[76:79], v[108:111]
    ds_read_b128 v[28:31], v8 offset:20480
    s_waitcnt lgkmcnt(4)
    v_mfma_f32_16x16x32_bf16 v[92:95], v[32:35], v[72:75], v[92:95]
    v_mfma_f32_16x16x32_bf16 v[112:115], v[32:35], v[76:79], v[112:115]
    ds_read_b128 v[32:35], v8 offset:21504
    s_waitcnt lgkmcnt(4)
    v_mfma_f32_16x16x32_bf16 v[96:99], v[36:39], v[72:75], v[96:99]
    v_mfma_f32_16x16x32_bf16 v[116:119], v[36:39], v[76:79], v[116:119]
    ds_read_b128 v[36:39], v8 offset:22528
    s_waitcnt lgkmcnt(4)
    v_mfma_f32_16x16x32_bf16 v[100:103], v[40:43], v[72:75], v[100:103]
    v_mfma_f32_16x16x32_bf16 v[120:123], v[40:43], v[76:79], v[120:123]
    ds_read_b128 v[40:43], v8 offset:23552
    s_waitcnt lgkmcnt(4)
    v_mfma_f32_16x16x32_bf16 v[104:107], v[44:47], v[72:75], v[104:107]
    v_mfma_f32_16x16x32_bf16 v[124:127], v[44:47], v[76:79], v[124:127]
    ds_read_b128 v[44:47], v8 offset:24576
    s_waitcnt lgkmcnt(4)
    v_mfma_f32_16x16x32_bf16 v[88:91], v[28:31], v[80:83], v[88:91]
    v_mfma_f32_16x16x32_bf16 v[108:111], v[28:31], v[84:87], v[108:111]
    s_waitcnt lgkmcnt(3)
    v_mfma_f32_16x16x32_bf16 v[92:95], v[32:35], v[80:83], v[92:95]
    v_mfma_f32_16x16x32_bf16 v[112:115], v[32:35], v[84:87], v[112:115]
    s_waitcnt lgkmcnt(2)
    v_mfma_f32_16x16x32_bf16 v[96:99], v[36:39], v[80:83], v[96:99]
    v_mfma_f32_16x16x32_bf16 v[116:119], v[36:39], v[84:87], v[116:119]
    s_waitcnt lgkmcnt(1)
    v_mfma_f32_16x16x32_bf16 v[100:103], v[40:43], v[80:83], v[100:103]
    v_mfma_f32_16x16x32_bf16 v[120:123], v[40:43], v[84:87], v[120:123]
    s_waitcnt lgkmcnt(0)
    v_mfma_f32_16x16x32_bf16 v[104:107], v[44:47], v[80:83], v[104:107]
    v_mfma_f32_16x16x32_bf16 v[124:127], v[44:47], v[84:87], v[124:127]
    v_add_u32 v7, s73, v2
    s_waitcnt lgkmcnt(0)
    s_barrier
    s_nop 4
    ds_write_b128 v7, v[88:91] offset:0
    ds_write_b128 v7, v[92:95] offset:1024
    ds_write_b128 v7, v[96:99] offset:2048
    ds_write_b128 v7, v[100:103] offset:3072
    ds_write_b128 v7, v[104:107] offset:4096
    ds_write_b128 v7, v[108:111] offset:5120
    ds_write_b128 v7, v[112:115] offset:6144
    ds_write_b128 v7, v[116:119] offset:7168
    ds_write_b128 v7, v[120:123] offset:8192
    ds_write_b128 v7, v[124:127] offset:9216
    v_lshlrev_b32 v28, 16, v20
    v_and_b32 v29, 0xffff0000, v20
    v_lshlrev_b32 v30, 16, v21
    v_and_b32 v31, 0xffff0000, v21
    v_lshlrev_b32 v32, 16, v22
    v_and_b32 v33, 0xffff0000, v22
    v_lshlrev_b32 v34, 16, v23
    v_and_b32 v35, 0xffff0000, v23
    v_lshlrev_b32 v36, 16, v24
    v_and_b32 v37, 0xffff0000, v24
    v_lshlrev_b32 v38, 16, v25
    v_and_b32 v39, 0xffff0000, v25
    s_waitcnt lgkmcnt(0)
    s_barrier
    v_lshlrev_b32 v96, 16, v14
    v_and_b32 v97, 0xffff0000, v14
    v_lshlrev_b32 v98, 16, v15
    v_and_b32 v99, 0xffff0000, v15
    v_lshlrev_b32 v100, 16, v16
    v_and_b32 v101, 0xffff0000, v16
    v_lshlrev_b32 v102, 16, v17
    v_and_b32 v103, 0xffff0000, v17
    v_lshlrev_b32 v104, 16, v18
    v_and_b32 v105, 0xffff0000, v18
    v_lshlrev_b32 v106, 16, v19
    v_and_b32 v107, 0xffff0000, v19
    ds_read_b128 v[48:51], v4 offset:0
    ds_read_b128 v[52:55], v4 offset:20480
    ds_read_b128 v[56:59], v4 offset:40960
    ds_read_b128 v[60:63], v4 offset:61440
    ds_read_b128 v[64:67], v4 offset:8192
    ds_read_b128 v[68:71], v4 offset:28672
    ds_read_b128 v[72:75], v4 offset:49152
    ds_read_b128 v[76:79], v6 offset:53248
    ds_read_b128 v[80:83], v6 offset:0
    ds_read_b128 v[84:87], v6 offset:20480
    ds_read_b128 v[88:91], v6 offset:40960
    ds_read_b128 v[92:95], v6 offset:61440
    s_waitcnt lgkmcnt(0)
    v_add_f32 v48, v48, v52
    v_add_f32 v49, v49, v53
    v_add_f32 v50, v50, v54
    v_add_f32 v51, v51, v55
    v_add_f32 v56, v56, v60
    v_add_f32 v57, v57, v61
    v_add_f32 v58, v58, v62
    v_add_f32 v59, v59, v63
    v_add_f32 v48, v48, v56
    v_add_f32 v49, v49, v57
    v_add_f32 v50, v50, v58
    v_add_f32 v51, v51, v59
    v_add_f32 v64, v64, v68
    v_add_f32 v65, v65, v69
    v_add_f32 v66, v66, v70
    v_add_f32 v67, v67, v71
    v_add_f32 v72, v72, v76
    v_add_f32 v73, v73, v77
    v_add_f32 v74, v74, v78
    v_add_f32 v75, v75, v79
    v_add_f32 v64, v64, v72
    v_add_f32 v65, v65, v73
    v_add_f32 v66, v66, v74
    v_add_f32 v67, v67, v75
    v_add_f32 v80, v80, v84
    v_add_f32 v81, v81, v85
    v_add_f32 v82, v82, v86
    v_add_f32 v83, v83, v87
    v_add_f32 v88, v88, v92
    v_add_f32 v89, v89, v93
    v_add_f32 v90, v90, v94
    v_add_f32 v91, v91, v95
    v_add_f32 v80, v80, v88
    v_add_f32 v81, v81, v89
    v_add_f32 v82, v82, v90
    v_add_f32 v83, v83, v91
    v_fmac_f32 v28, v48, v96
    v_fmac_f32 v29, v49, v97
    v_fmac_f32 v30, v50, v98
    v_fmac_f32 v31, v51, v99
    v_fmac_f32 v32, v64, v100
    v_fmac_f32 v33, v65, v101
    v_fmac_f32 v34, v66, v102
    v_fmac_f32 v35, v67, v103
    v_fmac_f32 v36, v80, v104
    v_fmac_f32 v37, v81, v105
    v_fmac_f32 v38, v82, v106
    v_fmac_f32 v39, v83, v107
    v_cvt_pk_bf16_f32 v20, v28, v29
    v_cvt_pk_bf16_f32 v21, v30, v31
    v_cvt_pk_bf16_f32 v22, v32, v33
    v_cvt_pk_bf16_f32 v23, v34, v35
    v_cvt_pk_bf16_f32 v24, v36, v37
    v_cvt_pk_bf16_f32 v25, v38, v39
    buffer_store_dwordx2 v[20:21], v11, s[20:23], s72 offen
    buffer_store_dwordx2 v[22:23], v12, s[20:23], s72 offen
    s_cmp_ge_u32 s3, 4
    s_cbranch_scc1 F3_FIN
    buffer_store_dwordx2 v[24:25], v13, s[20:23], s72 offen
F3_FIN:
    s_endpgm
AUX_2:
    s_setprio 3
    s_cmp_ge_u32 s30, 6
    s_cbranch_scc1 A_GO
    s_and_b32 s70, s30, 1
    s_lshl_b32 s70, s70, 5
    s_add_u32 s70, s70, s29
AUX_CS:
    s_cmp_lt_u32 s70, 27
    s_cselect_b32 s20, s48, s50
    s_cselect_b32 s21, s49, s51
    s_cselect_b32 s61, 0, 27
    s_cselect_b32 s82, 0, 7168
    s_cmp_lt_u32 s70, 54
    s_cselect_b32 s20, s20, s38
    s_cselect_b32 s21, s21, s39
    s_cselect_b32 s61, s61, 54
    s_cselect_b32 s82, s82, 14336
    s_mov_b32 s22, 0xc8000
    s_cmov_b32 s22, 0x21c000
    s_mov_b32 s62, 0x500
    s_cmov_b32 s62, 0xd80
    s_mov_b32 s23, 0x20000
    s_sub_u32 s61, s70, s61
    s_mul_i32 s60, s3, s62
    s_mul_i32 s60, s60, 80
    s_lshl_b32 s63, s61, 7
    s_add_u32 s60, s60, s63
    s_lshl_b32 s63, s61, 8
    s_add_u32 s82, s82, s63
    s_add_u32 s82, s82, 0x2c8000
    s_lshl_b32 s83, s70, 7
    s_add_u32 s83, s83, 0x5be000
    v_lshrrev_b32 v4, 3, v1
    v_mul_lo_u32 v4, v4, s62
    s_lshl_b32 s62, s62, 3
    v_and_b32 v5, 7, v1
    v_lshl_add_u32 v4, v5, 4, v4
    buffer_load_dwordx4 v[16:19], v4, s[20:23], s60 offen
    s_add_u32 s60, s60, s62
    buffer_load_dwordx4 v[20:23], v4, s[20:23], s60 offen
    s_add_u32 s60, s60, s62
    buffer_load_dwordx4 v[24:27], v4, s[20:23], s60 offen
    s_add_u32 s60, s60, s62
    buffer_load_dwordx4 v[28:31], v4, s[20:23], s60 offen
    s_add_u32 s60, s60, s62
    buffer_load_dwordx4 v[32:35], v4, s[20:23], s60 offen
    s_add_u32 s60, s60, s62
    buffer_load_dwordx4 v[36:39], v4, s[20:23], s60 offen
    s_add_u32 s60, s60, s62
    buffer_load_dwordx4 v[40:43], v4, s[20:23], s60 offen
    s_add_u32 s60, s60, s62
    buffer_load_dwordx4 v[44:47], v4, s[20:23], s60 offen
    s_add_u32 s60, s60, s62
    buffer_load_dwordx4 v[48:51], v4, s[20:23], s60 offen
    s_add_u32 s60, s60, s62
    buffer_load_dwordx4 v[52:55], v4, s[20:23], s60 offen
    s_add_u32 s60, s60, s62
    v_mov_b32 v8, 0
    v_mov_b32 v9, 0
    v_mov_b32 v10, 0
    v_mov_b32 v11, 0
    v_mov_b32 v12, 0
    v_mov_b32 v13, 0
    v_mov_b32 v14, 0
    v_mov_b32 v15, 0
    s_waitcnt vmcnt(9)
    v_lshlrev_b32 v6, 16, v16
    v_and_b32 v7, 0xffff0000, v16
    v_add_f32 v8, v8, v6
    v_add_f32 v9, v9, v7
    v_lshlrev_b32 v6, 16, v17
    v_and_b32 v7, 0xffff0000, v17
    v_add_f32 v10, v10, v6
    v_add_f32 v11, v11, v7
    v_lshlrev_b32 v6, 16, v18
    v_and_b32 v7, 0xffff0000, v18
    v_add_f32 v12, v12, v6
    v_add_f32 v13, v13, v7
    v_lshlrev_b32 v6, 16, v19
    v_and_b32 v7, 0xffff0000, v19
    v_add_f32 v14, v14, v6
    v_add_f32 v15, v15, v7
    s_waitcnt vmcnt(8)
    v_lshlrev_b32 v6, 16, v20
    v_and_b32 v7, 0xffff0000, v20
    v_add_f32 v8, v8, v6
    v_add_f32 v9, v9, v7
    v_lshlrev_b32 v6, 16, v21
    v_and_b32 v7, 0xffff0000, v21
    v_add_f32 v10, v10, v6
    v_add_f32 v11, v11, v7
    v_lshlrev_b32 v6, 16, v22
    v_and_b32 v7, 0xffff0000, v22
    v_add_f32 v12, v12, v6
    v_add_f32 v13, v13, v7
    v_lshlrev_b32 v6, 16, v23
    v_and_b32 v7, 0xffff0000, v23
    v_add_f32 v14, v14, v6
    v_add_f32 v15, v15, v7
    s_waitcnt vmcnt(7)
    v_lshlrev_b32 v6, 16, v24
    v_and_b32 v7, 0xffff0000, v24
    v_add_f32 v8, v8, v6
    v_add_f32 v9, v9, v7
    v_lshlrev_b32 v6, 16, v25
    v_and_b32 v7, 0xffff0000, v25
    v_add_f32 v10, v10, v6
    v_add_f32 v11, v11, v7
    v_lshlrev_b32 v6, 16, v26
    v_and_b32 v7, 0xffff0000, v26
    v_add_f32 v12, v12, v6
    v_add_f32 v13, v13, v7
    v_lshlrev_b32 v6, 16, v27
    v_and_b32 v7, 0xffff0000, v27
    v_add_f32 v14, v14, v6
    v_add_f32 v15, v15, v7
    s_waitcnt vmcnt(6)
    v_lshlrev_b32 v6, 16, v28
    v_and_b32 v7, 0xffff0000, v28
    v_add_f32 v8, v8, v6
    v_add_f32 v9, v9, v7
    v_lshlrev_b32 v6, 16, v29
    v_and_b32 v7, 0xffff0000, v29
    v_add_f32 v10, v10, v6
    v_add_f32 v11, v11, v7
    v_lshlrev_b32 v6, 16, v30
    v_and_b32 v7, 0xffff0000, v30
    v_add_f32 v12, v12, v6
    v_add_f32 v13, v13, v7
    v_lshlrev_b32 v6, 16, v31
    v_and_b32 v7, 0xffff0000, v31
    v_add_f32 v14, v14, v6
    v_add_f32 v15, v15, v7
    s_waitcnt vmcnt(5)
    v_lshlrev_b32 v6, 16, v32
    v_and_b32 v7, 0xffff0000, v32
    v_add_f32 v8, v8, v6
    v_add_f32 v9, v9, v7
    v_lshlrev_b32 v6, 16, v33
    v_and_b32 v7, 0xffff0000, v33
    v_add_f32 v10, v10, v6
    v_add_f32 v11, v11, v7
    v_lshlrev_b32 v6, 16, v34
    v_and_b32 v7, 0xffff0000, v34
    v_add_f32 v12, v12, v6
    v_add_f32 v13, v13, v7
    v_lshlrev_b32 v6, 16, v35
    v_and_b32 v7, 0xffff0000, v35
    v_add_f32 v14, v14, v6
    v_add_f32 v15, v15, v7
    s_waitcnt vmcnt(4)
    v_lshlrev_b32 v6, 16, v36
    v_and_b32 v7, 0xffff0000, v36
    v_add_f32 v8, v8, v6
    v_add_f32 v9, v9, v7
    v_lshlrev_b32 v6, 16, v37
    v_and_b32 v7, 0xffff0000, v37
    v_add_f32 v10, v10, v6
    v_add_f32 v11, v11, v7
    v_lshlrev_b32 v6, 16, v38
    v_and_b32 v7, 0xffff0000, v38
    v_add_f32 v12, v12, v6
    v_add_f32 v13, v13, v7
    v_lshlrev_b32 v6, 16, v39
    v_and_b32 v7, 0xffff0000, v39
    v_add_f32 v14, v14, v6
    v_add_f32 v15, v15, v7
    s_waitcnt vmcnt(3)
    v_lshlrev_b32 v6, 16, v40
    v_and_b32 v7, 0xffff0000, v40
    v_add_f32 v8, v8, v6
    v_add_f32 v9, v9, v7
    v_lshlrev_b32 v6, 16, v41
    v_and_b32 v7, 0xffff0000, v41
    v_add_f32 v10, v10, v6
    v_add_f32 v11, v11, v7
    v_lshlrev_b32 v6, 16, v42
    v_and_b32 v7, 0xffff0000, v42
    v_add_f32 v12, v12, v6
    v_add_f32 v13, v13, v7
    v_lshlrev_b32 v6, 16, v43
    v_and_b32 v7, 0xffff0000, v43
    v_add_f32 v14, v14, v6
    v_add_f32 v15, v15, v7
    s_waitcnt vmcnt(2)
    v_lshlrev_b32 v6, 16, v44
    v_and_b32 v7, 0xffff0000, v44
    v_add_f32 v8, v8, v6
    v_add_f32 v9, v9, v7
    v_lshlrev_b32 v6, 16, v45
    v_and_b32 v7, 0xffff0000, v45
    v_add_f32 v10, v10, v6
    v_add_f32 v11, v11, v7
    v_lshlrev_b32 v6, 16, v46
    v_and_b32 v7, 0xffff0000, v46
    v_add_f32 v12, v12, v6
    v_add_f32 v13, v13, v7
    v_lshlrev_b32 v6, 16, v47
    v_and_b32 v7, 0xffff0000, v47
    v_add_f32 v14, v14, v6
    v_add_f32 v15, v15, v7
    s_waitcnt vmcnt(1)
    v_lshlrev_b32 v6, 16, v48
    v_and_b32 v7, 0xffff0000, v48
    v_add_f32 v8, v8, v6
    v_add_f32 v9, v9, v7
    v_lshlrev_b32 v6, 16, v49
    v_and_b32 v7, 0xffff0000, v49
    v_add_f32 v10, v10, v6
    v_add_f32 v11, v11, v7
    v_lshlrev_b32 v6, 16, v50
    v_and_b32 v7, 0xffff0000, v50
    v_add_f32 v12, v12, v6
    v_add_f32 v13, v13, v7
    v_lshlrev_b32 v6, 16, v51
    v_and_b32 v7, 0xffff0000, v51
    v_add_f32 v14, v14, v6
    v_add_f32 v15, v15, v7
    s_waitcnt vmcnt(0)
    v_lshlrev_b32 v6, 16, v52
    v_and_b32 v7, 0xffff0000, v52
    v_add_f32 v8, v8, v6
    v_add_f32 v9, v9, v7
    v_lshlrev_b32 v6, 16, v53
    v_and_b32 v7, 0xffff0000, v53
    v_add_f32 v10, v10, v6
    v_add_f32 v11, v11, v7
    v_lshlrev_b32 v6, 16, v54
    v_and_b32 v7, 0xffff0000, v54
    v_add_f32 v12, v12, v6
    v_add_f32 v13, v13, v7
    v_lshlrev_b32 v6, 16, v55
    v_and_b32 v7, 0xffff0000, v55
    v_add_f32 v14, v14, v6
    v_add_f32 v15, v15, v7
    v_mov_b32 v7, 0
    buffer_load_dword v3, v7, s[24:27], 0 offen sc1
    v_lshlrev_b32 v4, 5, v0
    ds_write_b128 v4, v[8:11]
    ds_write_b128 v4, v[12:15] offset:16
    v_lshrrev_b32 v5, 6, v0
    v_and_b32 v6, 63, v0
    v_lshlrev_b32 v6, 2, v6
    v_lshl_add_u32 v5, v5, 11, v6
    s_waitcnt lgkmcnt(0)
    s_barrier
    ds_read_b32 v16, v5 offset:0
    ds_read_b32 v17, v5 offset:256
    ds_read_b32 v18, v5 offset:512
    ds_read_b32 v19, v5 offset:768
    ds_read_b32 v20, v5 offset:1024
    ds_read_b32 v21, v5 offset:1280
    ds_read_b32 v22, v5 offset:1536
    ds_read_b32 v23, v5 offset:1792
    v_lshlrev_b32 v4, 2, v0
    s_waitcnt lgkmcnt(0)
    v_add_f32 v16, v16, v17
    v_add_f32 v18, v18, v19
    v_add_f32 v20, v20, v21
    v_add_f32 v22, v22, v23
    v_add_f32 v16, v16, v18
    v_add_f32 v20, v20, v22
    v_add_f32 v16, v16, v20
    ds_write_b32 v5, v16
    s_waitcnt lgkmcnt(0)
    s_barrier
    s_cmp_lg_u32 s3, 0
    s_cbranch_scc1 SP_CD
    ds_read_b32 v16, v4 offset:0
    ds_read_b32 v17, v4 offset:2048
    ds_read_b32 v18, v4 offset:4096
    ds_read_b32 v19, v4 offset:6144
    ds_read_b32 v20, v4 offset:8192
    ds_read_b32 v21, v4 offset:10240
    ds_read_b32 v22, v4 offset:12288
    ds_read_b32 v23, v4 offset:14336
    s_waitcnt lgkmcnt(0)
    v_add_f32 v16, v16, v17
    v_add_f32 v18, v18, v19
    v_add_f32 v20, v20, v21
    v_add_f32 v22, v22, v23
    v_add_f32 v16, v16, v18
    v_add_f32 v20, v20, v22
    v_add_f32 v16, v16, v20
    buffer_store_dword v16, v4, s[8:11], s82 offen offset:0 sc1
    s_mov_b32 s66, 16384
    v_mov_b32 v7, 0
GL_44:
    s_waitcnt vmcnt(0)
    v_cmp_ne_u32 vcc, 0, v3
    s_nop 0
    s_cbranch_vccnz GK_45
    buffer_load_dword v3, v7, s[24:27], 0 offen sc1
    s_sub_u32 s66, s66, 1
    s_cmp_lg_u32 s66, 0
    s_cbranch_scc1 GL_44
GK_45:
    s_mov_b64 exec, 1
    buffer_store_dword v3, v7, s[8:11], s83 offen sc1
    s_mov_b64 exec, -1
SP_CD:
    s_branch A_GO
AUX_RL:
    s_setprio 1
    s_lshl_b32 s70, s30, 5
    s_add_u32 s70, s70, s29
    s_cmp_lt_u32 s3, 2
    s_cbranch_scc1 AUX_RD
    v_lshrrev_b32 v4, 3, v1
    v_mul_u32_u24 v4, 1280, v4
    v_and_b32 v5, 7, v1
    v_lshl_add_u32 v126, v5, 4, v4
    s_lshl_b32 s72, s3, 12
    s_cmp_ge_u32 s3, 4
    s_cselect_b32 s60, 8192, 0
    s_add_u32 s72, s72, s60
    v_lshrrev_b32 v4, 4, v1
    v_bfe_u32 v5, v1, 2, 2
    v_lshl_add_u32 v4, v4, 3, v5
    v_lshlrev_b32 v4, 7, v4
    v_and_b32 v5, 3, v1
    v_lshl_add_u32 v4, v5, 3, v4
    v_add_u32 v127, s72, v4
    s_mul_i32 s71, s70, 6
    s_add_u32 s71, s71, s3
    s_sub_u32 s71, s71, 2
    s_mov_b32 s19, 0x20000
    s_mul_hi_u32 s61, s71, 0x1999999a
    s_mul_i32 s62, s61, 10
    s_sub_u32 s62, s71, s62
    s_lshl_b32 s63, s62, 2
    s_add_u32 s63, s63, 0
    s_mul_hi_u32 s64, s63, 0x33333334
    s_mul_i32 s64, s64, 365
    s_add_u32 s64, s64, s63
    s_mul_i32 s63, s61, 5
    s_add_u32 s64, s64, s63
    s_lshl_b32 s64, s64, 10
    s_add_u32 s74, s64, 0x2d0000
    s_lshl_b32 s63, s62, 2
    s_add_u32 s63, s63, 1
    s_mul_hi_u32 s64, s63, 0x33333334
    s_mul_i32 s64, s64, 365
    s_add_u32 s64, s64, s63
    s_mul_i32 s63, s61, 5
    s_add_u32 s64, s64, s63
    s_lshl_b32 s64, s64, 10
    s_add_u32 s75, s64, 0x2d0000
    s_lshl_b32 s63, s62, 2
    s_add_u32 s63, s63, 2
    s_mul_hi_u32 s64, s63, 0x33333334
    s_mul_i32 s64, s64, 365
    s_add_u32 s64, s64, s63
    s_mul_i32 s63, s61, 5
    s_add_u32 s64, s64, s63
    s_lshl_b32 s64, s64, 10
    s_add_u32 s76, s64, 0x2d0000
    s_lshl_b32 s63, s62, 2
    s_add_u32 s63, s63, 3
    s_mul_hi_u32 s64, s63, 0x33333334
    s_mul_i32 s64, s64, 365
    s_add_u32 s64, s64, s63
    s_mul_i32 s63, s61, 5
    s_add_u32 s64, s64, s63
    s_lshl_b32 s64, s64, 10
    s_add_u32 s77, s64, 0x2d0000
    s_sub_u32 s64, s61, 54
    s_cmp_lt_u32 s61, 54
    s_cselect_b32 s61, s61, s64
    s_cselect_b32 s16, s52, s44
    s_cselect_b32 s17, s53, s45
    s_mov_b32 s18, 0xc8000
    s_cmov_b32 s18, 0x21c000
    s_mul_i32 s61, s61, 40960
    s_lshl_b32 s62, s62, 7
    s_add_u32 s61, s61, s62
    s_cmp_lt_u32 s71, 740
    s_cselect_b32 s74, s74, 0x40000000
    s_cselect_b32 s75, s75, 0x40000000
    s_cselect_b32 s76, s76, 0x40000000
    s_cselect_b32 s77, s77, 0x40000000
    s_add_u32 m0, s72, 0
    s_nop 0
    buffer_load_dwordx4 v126, s[16:19], s61 offen lds
    s_add_u32 s61, s61, 10240
    s_add_u32 m0, s72, 1024
    s_nop 0
    buffer_load_dwordx4 v126, s[16:19], s61 offen lds
    s_add_u32 s61, s61, 10240
    s_add_u32 m0, s72, 2048
    s_nop 0
    buffer_load_dwordx4 v126, s[16:19], s61 offen lds
    s_add_u32 s61, s61, 10240
    s_add_u32 m0, s72, 3072
    s_nop 0
    buffer_load_dwordx4 v126, s[16:19], s61 offen lds
    s_add_u32 s61, s61, 10240
    s_add_u32 s71, s71, 512
    s_waitcnt vmcnt(0)
    ds_read_b64_tr_b16 v[16:17], v127 offset:0
    ds_read_b64_tr_b16 v[18:19], v127 offset:512
    ds_read_b64_tr_b16 v[20:21], v127 offset:32
    ds_read_b64_tr_b16 v[22:23], v127 offset:544
    ds_read_b64_tr_b16 v[24:25], v127 offset:64
    ds_read_b64_tr_b16 v[26:27], v127 offset:576
    ds_read_b64_tr_b16 v[28:29], v127 offset:96
    ds_read_b64_tr_b16 v[30:31], v127 offset:608
    s_waitcnt lgkmcnt(0)
    buffer_store_dwordx4 v[16:19], v2, s[8:11], s74 offen sc1
    buffer_store_dwordx4 v[20:23], v2, s[8:11], s75 offen sc1
    buffer_store_dwordx4 v[24:27], v2, s[8:11], s76 offen sc1
    buffer_store_dwordx4 v[28:31], v2, s[8:11], s77 offen sc1
AUX_RD:
    s_lshl_b32 s60, s70, 7
    s_add_u32 s60, s60, 0x5b8000
    v_mov_b32 v7, 0
    buffer_load_dword v3, v7, s[24:27], 0 offen sc1
    s_waitcnt vmcnt(0)
    s_barrier
    s_cmp_lg_u32 s3, 0
    s_cbranch_scc1 FD_46
    s_mov_b32 s66, 16384
    v_mov_b32 v7, 0
GL_47:
    s_waitcnt vmcnt(0)
    v_cmp_ne_u32 vcc, 0, v3
    s_nop 0
    s_cbranch_vccnz GK_48
    buffer_load_dword v3, v7, s[24:27], 0 offen sc1
    s_sub_u32 s66, s66, 1
    s_cmp_lg_u32 s66, 0
    s_cbranch_scc1 GL_47
GK_48:
    s_mov_b64 exec, 1
    buffer_store_dword v3, v7, s[8:11], s60 offen sc1
    s_mov_b64 exec, -1
FD_46:
    s_branch A_GO
.section .rodata,"a"
.p2align 6
.amdhsa_kernel recurrent_scan__grouped_kv_mqa__swiglu_ffn__prompt_kernel
  .amdhsa_next_free_vgpr 128
  .amdhsa_next_free_sgpr 102
  .amdhsa_accum_offset 128
  .amdhsa_group_segment_fixed_size 0
  .amdhsa_kernarg_size 96
  .amdhsa_user_sgpr_count 2
  .amdhsa_user_sgpr_kernarg_segment_ptr 1
  .amdhsa_system_sgpr_workgroup_id_x 1
.end_amdhsa_kernel
```
